```python
import torch

def _softmax(x, axis=-1):
    return torch.softmax(x, dim=axis)
def _gelu(x):
    return torch.nn.functional.gelu(x, approximate="tanh")
def _silu(x):
    return torch.nn.functional.silu(x)
def _sigmoid(x):
    return torch.sigmoid(x)
def _layernorm(x, axis=-1, eps=1e-5):
    m = x.mean(dim=axis, keepdim=True)
    v = x.var(dim=axis, keepdim=True, unbiased=False)
    return (x - m) / torch.sqrt(v + eps)
def _scatter_add(tgt, idx, src, axis=0):
    return tgt.clone().index_add_(axis, idx, src)
def _segment_sum(src, seg, n):
    out = torch.zeros((n,) + src.shape[1:], dtype=src.dtype)
    return out.index_add_(0, seg, src)
def _pad(x, pw):
    flat = tuple(v for pair in reversed(pw) for v in pair)
    return torch.nn.functional.pad(x, flat)

kernel_name = 'parallel_sum__sliding_block_cached__glu_gated_reglu__decode'

def setup_inputs():

    _w = (lambda a: (lambda t: t.to(torch.bfloat16) if t.is_floating_point() else t)(torch.as_tensor(a)))
    def _A_setup():
        B, Sq, D = 2, 1, 576
        Hq, Hkv, Sk, Dh = 32, 16, 8192, 128
        assert Hq % Hkv == 0, (Hq, Hkv)
        return {
            "x": _w((lambda *s: torch.randn(*s, dtype=torch.bfloat16) * 0.05)(B, Sq, D)),
            "k_cache": _w((lambda *s: torch.randn(*s, dtype=torch.bfloat16) * 1.6)(B, Hkv, Sk, Dh)),
            "v_cache": _w((lambda *s: torch.randn(*s, dtype=torch.bfloat16) * 0.8)(B, Hkv, Sk, Dh)),
            "wq": _w((lambda *s: torch.randn(*s, dtype=torch.bfloat16) * 1.6)(D, Hq * Dh) * (D ** -0.5)),
            "wo": _w((lambda *s: torch.randn(*s, dtype=torch.bfloat16) * 0.8)(Hq * Dh, D) * ((Hq * Dh) ** -0.5)),
        }
    _A_in = _A_setup()

    def _B_setup():
        B, S, D, F = 2, 1, 576, 4608
        return {
            "x": _w((lambda *s: torch.randn(*s, dtype=torch.bfloat16) * 0.05)(B, S, D)),
            "W_gate": _w((lambda *s: torch.randn(*s, dtype=torch.bfloat16) * 0.4)(D, F) * (2.0 / D) ** 0.5),
            "W_up": _w((lambda *s: torch.randn(*s, dtype=torch.bfloat16) * 0.4)(D, F) * (2.0 / D) ** 0.5),
            "W_down": _w((lambda *s: torch.randn(*s, dtype=torch.bfloat16) * 0.4)(F, D) * (1.0 / F) ** 0.5),
        }
    _B_in = _B_setup()

    return {
        "A_x": _A_in["x"],
        "A_k_cache": _A_in["k_cache"],
        "A_v_cache": _A_in["v_cache"],
        "A_wq": _A_in["wq"],
        "A_wo": _A_in["wo"],
        "B_x": _B_in["x"],
        "B_W_gate": _B_in["W_gate"],
        "B_W_up": _B_in["W_up"],
        "B_W_down": _B_in["W_down"],
    }

def reference(A_x, A_k_cache, A_v_cache, A_wq, A_wo, B_x, B_W_gate, B_W_up, B_W_down):
    def _A_ref(x, k_cache, v_cache, wq, wo):
        B, Sq, D = x.shape
        Hq, Dh = 32, 128
        Hkv, Sk = k_cache.shape[1], k_cache.shape[2]
        W = min(4096, max(256, Sk // 4))
        rep = Hq // Hkv
        q = (lambda x, *d: x.permute(*d))((x @ wq).reshape(B, Sq, Hq, Dh), 0, 2, 1, 3)
        k = (lambda x, n, axis: torch.repeat_interleave(x, n, dim=axis))(k_cache[:, :, Sk - W:, :], rep, axis=1)
        v = (lambda x, n, axis: torch.repeat_interleave(x, n, dim=axis))(v_cache[:, :, Sk - W:, :], rep, axis=1)
        scores = torch.einsum("bhqd,bhkd->bhqk", q, k) * (Dh ** -0.5)
        p = _softmax(scores, axis=-1)
        o = torch.einsum("bhqk,bhkd->bhqd", p, v)
        return (lambda x, *d: x.permute(*d))(o, 0, 2, 1, 3).reshape(B, Sq, Hq * Dh) @ wo

    def _B_ref(x, W_gate, W_up, W_down):
        gate = torch.einsum("bsd,df->bsf", x, W_gate)
        up = torch.einsum("bsd,df->bsf", x, W_up)
        gate = gate * (lambda x, dt: x.to(dt))(gate > 0, gate.dtype)
        h = gate * up
        return torch.einsum("bsf,fd->bsd", h, W_down)

    x = A_x
    xn = _layernorm(x, axis=-1)
    return x + _A_ref(xn, A_k_cache, A_v_cache, A_wq, A_wo) + _B_ref(xn, B_W_gate, B_W_up, B_W_down)
```

```asm
; @launch grid=(256,1,1) block=(768,1,1) lds=40960
.amdgcn_target "amdgcn-amd-amdhsa--gfx950"
.text
.globl parallel_sum__sliding_block_cached__glu_gated_reglu__decode_kernel
.p2align 8
.type parallel_sum__sliding_block_cached__glu_gated_reglu__decode_kernel,@function
parallel_sum__sliding_block_cached__glu_gated_reglu__decode_kernel:
    s_cmp_ge_u32 s2, 256
    s_cbranch_scc1 END
    s_load_dwordx2 s[4:5], s[0:1], 0
    s_load_dwordx2 s[16:17], s[0:1], 24
    s_load_dwordx2 s[8:9], s[0:1], 8
    s_load_dwordx2 s[40:41], s[0:1], 88
    s_load_dwordx2 s[12:13], s[0:1], 16
    s_load_dwordx2 s[24:25], s[0:1], 48
    s_load_dwordx2 s[28:29], s[0:1], 56
    s_load_dwordx2 s[20:21], s[0:1], 32
    s_load_dwordx2 s[32:33], s[0:1], 64
    s_load_dwordx2 s[36:37], s[0:1], 72
    v_lshrrev_b32 v2, 6, v0
    v_and_b32 v1, 63, v0
    v_readfirstlane_b32 s56, v2
    s_mov_b32 s6, 2304
    s_mov_b32 s7, 0x20000
    s_mov_b32 s18, 4718592
    s_mov_b32 s19, 0x20000
    s_mov_b32 s10, 67108864
    s_mov_b32 s11, 0x20000
    s_mov_b32 s42, 268435456
    s_mov_b32 s43, 0x20000
    s_mov_b32 s14, 67108864
    s_mov_b32 s15, 0x20000
    s_mov_b32 s26, 5308416
    s_mov_b32 s27, 0x20000
    s_mov_b32 s30, 5308416
    s_mov_b32 s31, 0x20000
    s_mov_b32 s22, 4718592
    s_mov_b32 s23, 0x20000
    s_mov_b32 s34, 5308416
    s_mov_b32 s35, 0x20000
    s_mov_b32 s38, 2304
    s_mov_b32 s39, 0x20000
    v_and_b32 v3, 15, v1
    v_lshrrev_b32 v4, 4, v1
    v_lshlrev_b32 v6, 4, v1
    s_and_b32 s57, s2, 7
    s_lshr_b32 s58, s2, 3
    s_lshr_b32 s67, s58, 4
    s_lshl_b32 s59, s57, 1
    s_add_u32 s59, s59, s67
    s_and_b32 s60, s58, 15
    s_lshr_b32 s61, s60, 3
    s_and_b32 s62, s60, 7
    v_mov_b32 v16, 0xff
    s_mov_b32 s87, 0xffffff00
    s_mov_b32 s75, 0x0c0c0400
    s_mov_b32 s76, 0x04000c0c
    s_mov_b32 s78, 0x3fb8aa3b
    s_cmp_lt_u32 s56, 4
    s_cbranch_scc1 SERVICE
STREAM:
    s_sub_u32 s56, s56, 4
    v_subrev_u32 v2, 4, v2
    v_subrev_u32 v0, 256, v0
    v_lshlrev_b32 v7, 13, v4
    v_lshl_add_u32 v7, v3, 4, v7
    s_lshl_b32 s81, s56, 3
    s_add_u32 s81, s81, s62
    s_lshl_b32 s81, s81, 2
    s_lshl_b32 s69, s81, 2
    s_lshl_b32 s81, s81, 13
    s_lshl_b32 s67, s59, 1
    s_add_u32 s67, s67, s61
    s_lshl_b32 s67, s67, 8
    s_add_u32 s81, s81, s67
    s_add_u32 s82, s81, 2097152
    s_add_u32 s83, s81, 4194304
    s_cmp_lt_u32 s56, 2
    s_cselect_b32 s83, s83, 1073741824
    s_lshl_b32 s65, s61, 4
    s_add_u32 s65, s65, s59
    s_lshl_b32 s65, s65, 21
    s_lshl_b32 s67, s62, 10
    s_add_u32 s65, s65, s67
    s_lshl_b32 s67, s56, 13
    s_add_u32 s65, s65, s67
    s_add_u32 s65, s65, 1572864
    v_lshrrev_b32 v5, 2, v3
    v_lshlrev_b32 v5, 8, v5
    v_and_b32 v79, 3, v3
    v_lshl_add_u32 v79, v4, 2, v79
    v_lshl_add_u32 v5, v79, 4, v5
    s_waitcnt lgkmcnt(0)
    s_load_dword s79, s[40:41], 0
    buffer_load_dwordx4 v[120:123], v7, s[16:19], s81 offen nt
    v_and_b32 v79, 1, v3
    v_mov_b32 v80, 0xffff
    v_mov_b32 v81, 0xffff0000
    v_cmp_eq_u32 vcc, 1, v79
    s_nop 1
    v_cndmask_b32 v80, v80, v81, vcc
    v_bfe_u32 v79, v3, 1, 2
    v_cmp_eq_u32 vcc, 0, v79
    s_nop 1
    v_cndmask_b32 v12, 0, v80, vcc
    v_cmp_eq_u32 vcc, 1, v79
    s_nop 1
    v_cndmask_b32 v13, 0, v80, vcc
    v_cmp_eq_u32 vcc, 2, v79
    s_nop 1
    v_cndmask_b32 v14, 0, v80, vcc
    v_cmp_eq_u32 vcc, 3, v79
    s_nop 1
    v_cndmask_b32 v15, 0, v80, vcc
    s_barrier
    buffer_load_dwordx4 v[124:127], v7, s[16:19], s82 offen nt
    v_lshrrev_b32 v79, 3, v3
    v_mul_u32_u24 v80, 576, v79
    v_add_lshl_u32 v80, v80, v4, 2
    v_add_u32 v17, s69, v80
    s_and_b32 s67, s56, 3
    s_lshl_b32 s68, s58, 2
    s_add_u32 s67, s67, s68
    s_mul_i32 s68, s67, 4682
    s_lshr_b32 s68, s68, 16
    s_mul_i32 s69, s68, 14
    s_sub_u32 s69, s67, s69
    s_lshl_b32 s84, s68, 7
    s_mul_i32 s68, s57, 1152
    s_add_u32 s84, s84, s68
    s_cmp_lt_u32 s67, 126
    s_cselect_b32 s84, s84, 1073741824
    s_mul_i32 s67, s69, 5
    s_cmp_gt_u32 s69, 0
    s_addc_u32 s67, s67, 0
    s_cmp_gt_u32 s69, 7
    s_addc_u32 s67, s67, 0
    s_mul_i32 s68, s67, 73728
    s_add_u32 s84, s84, s68
    s_add_u32 s53, s84, 368640
    s_cmp_eq_u32 s69, 0
    s_cselect_b32 s68, -1, 0
    s_cmp_eq_u32 s69, 7
    s_cselect_b32 s52, -1, s68
    s_cmp_lg_u32 s52, 0
    s_cselect_b32 s53, s53, 1073741824
    s_lshl_b32 s67, s67, 5
    v_mul_u32_u24 v80, 576, v79
    v_add_lshl_u32 v80, v80, v4, 2
    v_add_u32 v18, s67, v80
    s_barrier
    buffer_load_dwordx4 v[128:131], v7, s[16:19], s83 offen nt
    v_lshrrev_b32 v80, 3, v3
    v_lshl_add_u32 v80, v80, 2, v4
    v_mul_u32_u24 v8, 9216, v80
    v_and_b32 v80, 7, v3
    v_lshl_add_u32 v8, v80, 4, v8
    s_cmp_ge_u32 s56, 4
    s_cselect_b32 s48, s28, s24
    s_cselect_b32 s49, s29, s25
    s_cselect_b32 s50, s30, s26
    s_cselect_b32 s51, s31, s27
    s_barrier
    buffer_load_dwordx4 v[88:91], v5, s[8:11], s65 offen nt
    s_lshl_b32 s67, s59, 8
    s_lshl_b32 s68, s61, 7
    s_add_u32 s67, s67, s68
    s_add_u32 s67, s67, s62
    s_mul_i32 s85, s67, 1152
    s_mul_i32 s86, s57, 663552
    s_mul_i32 s55, s58, 9
    s_lshr_b32 s55, s55, 1
    s_bitcmp1_b32 s58, 0
    s_cselect_b32 s54, 0, 1073741824
    s_lshl_b32 s69, s56, 8
    s_cmp_lt_u32 s56, 5
    s_cselect_b32 s69, s69, 1073741824
    s_add_u32 s85, s85, s69
    s_add_u32 s86, s86, s69
    v_mul_u32_u24 v9, 9216, v4
    v_lshl_add_u32 v9, v3, 4, v9
    v_mov_b32 v81, 1073741824
    s_cmp_eq_u32 s56, 4
    s_cselect_b32 s67, 8, 16
    v_cmp_gt_u32 vcc, s67, v3
    s_nop 1
    v_cndmask_b32 v9, v81, v9, vcc
    v_mul_u32_u24 v19, 40, v79
    v_add_lshl_u32 v19, v19, v4, 2
    v_add_u32 v19, 4608, v19
    s_mov_b32 s77, 0x3db504f3
    s_waitcnt vmcnt(3)
    s_add_u32 s66, s65, 65536
    buffer_load_dwordx4 v[92:95], v5, s[8:11], s66 offen nt
    s_waitcnt vmcnt(3)
    s_add_u32 s66, s65, 131072
    buffer_load_dwordx4 v[96:99], v5, s[8:11], s66 offen nt
    s_waitcnt vmcnt(3)
    s_add_u32 s66, s65, 196608
    buffer_load_dwordx4 v[100:103], v5, s[8:11], s66 offen nt
    s_waitcnt lgkmcnt(0)
    s_mul_i32 s70, s79, 0x9E3779B1
    s_add_u32 s70, s70, 0x7F4A7C15
    s_bfe_u32 s71, s70, 0x80000
    s_bfe_u32 s72, s70, 0x80008
    s_bfe_u32 s73, s70, 0x80010
    s_bfe_u32 s74, s70, 0x80018
    s_barrier
    ds_read_b32 v78, v17 offset:0
    ds_read_b32 v79, v17 offset:1024
    ds_read_b32 v80, v17 offset:2048
    s_cmp_lt_u32 s56, 2
    s_cselect_b32 s67, -1, 0
    s_waitcnt lgkmcnt(0)
    v_and_b32 v80, s67, v80
    v_and_b32 v20, v78, v12
    v_and_b32 v21, v78, v13
    v_and_b32 v22, v78, v14
    v_and_b32 v23, v78, v15
    s_nop 1
    v_mfma_f32_16x16x32_bf16 v[56:59], v[120:123], v[20:23], 0
    v_and_b32 v24, v79, v12
    v_and_b32 v25, v79, v13
    v_and_b32 v26, v79, v14
    v_and_b32 v27, v79, v15
    s_nop 1
    v_mfma_f32_16x16x32_bf16 v[56:59], v[124:127], v[24:27], v[56:59]
    v_and_b32 v20, v80, v12
    v_and_b32 v21, v80, v13
    v_and_b32 v22, v80, v14
    v_and_b32 v23, v80, v15
    s_nop 1
    v_mfma_f32_16x16x32_bf16 v[56:59], v[128:131], v[20:23], v[56:59]
    v_lshlrev_b32 v81, 4, v0
    s_nop 6
    ds_write_b128 v81, v[56:59] offset:8192
    s_waitcnt lgkmcnt(0)
    s_barrier
    s_waitcnt vmcnt(3)
    s_add_u32 s66, s65, 262144
    buffer_load_dwordx4 v[104:107], v5, s[8:11], s66 offen nt
    s_waitcnt vmcnt(3)
    s_add_u32 s66, s65, 327680
    buffer_load_dwordx4 v[108:111], v5, s[8:11], s66 offen nt
    s_waitcnt vmcnt(3)
    s_add_u32 s66, s65, 393216
    buffer_load_dwordx4 v[112:115], v5, s[8:11], s66 offen nt
    s_waitcnt vmcnt(3)
    s_add_u32 s66, s65, 458752
    buffer_load_dwordx4 v[116:119], v5, s[8:11], s66 offen nt
    s_waitcnt vmcnt(3)
    buffer_load_dwordx4 v[120:123], v6, s[12:15], s65 offen nt
    s_cmp_eq_u32 s56, 0
    s_cbranch_scc0 SKIP_38
    v_mov_b32 v86, 5760
    v_mov_b32 v87, 1
    ds_write_b32 v86, v87
SKIP_38:
    s_waitcnt vmcnt(3)
    s_add_u32 s66, s65, 65536
    buffer_load_dwordx4 v[124:127], v6, s[12:15], s66 offen nt
    s_waitcnt vmcnt(3)
    s_add_u32 s66, s65, 131072
    buffer_load_dwordx4 v[128:131], v6, s[12:15], s66 offen nt
    s_waitcnt vmcnt(3)
    s_add_u32 s66, s65, 196608
    buffer_load_dwordx4 v[132:135], v6, s[12:15], s66 offen nt
    s_waitcnt vmcnt(3)
    s_add_u32 s66, s65, 262144
    buffer_load_dwordx4 v[136:139], v6, s[12:15], s66 offen nt
    s_waitcnt vmcnt(3)
    s_add_u32 s66, s65, 327680
    buffer_load_dwordx4 v[140:143], v6, s[12:15], s66 offen nt
    s_waitcnt vmcnt(3)
    s_add_u32 s66, s65, 393216
    buffer_load_dwordx4 v[144:147], v6, s[12:15], s66 offen nt
    s_waitcnt vmcnt(3)
    s_add_u32 s66, s65, 458752
    buffer_load_dwordx4 v[148:151], v6, s[12:15], s66 offen nt
    s_waitcnt vmcnt(3)
    buffer_load_dwordx4 v[152:155], v8, s[48:51], s53 offen nt
    s_waitcnt lgkmcnt(0)
    s_barrier
    v_lshrrev_b32 v78, 3, v3
    v_lshlrev_b32 v78, 8, v78
    v_and_b32 v79, 3, v3
    v_lshl_add_u32 v79, v4, 2, v79
    v_lshl_add_u32 v78, v79, 4, v78
    ds_read_b128 v[82:85], v78 offset:5120
    s_waitcnt lgkmcnt(0)
    v_mfma_f32_16x16x32_bf16 v[36:39], v[88:91], v[82:85], 0
    v_mfma_f32_16x16x32_bf16 v[40:43], v[92:95], v[82:85], 0
    v_mfma_f32_16x16x32_bf16 v[44:47], v[96:99], v[82:85], 0
    v_mfma_f32_16x16x32_bf16 v[48:51], v[100:103], v[82:85], 0
    s_nop 4
    v_mov_b32_dpp v60, v36 quad_perm:[0,0,0,0] row_mask:0xf bank_mask:0xf
    v_mov_b32_dpp v61, v40 quad_perm:[0,0,0,0] row_mask:0xf bank_mask:0xf
    v_mov_b32_dpp v62, v44 quad_perm:[0,0,0,0] row_mask:0xf bank_mask:0xf
    v_mov_b32_dpp v63, v48 quad_perm:[0,0,0,0] row_mask:0xf bank_mask:0xf
    v_add_f32_dpp v60, v37, v60 quad_perm:[1,1,1,1] row_mask:0xf bank_mask:0xf
    v_add_f32_dpp v61, v41, v61 quad_perm:[1,1,1,1] row_mask:0xf bank_mask:0xf
    v_add_f32_dpp v62, v45, v62 quad_perm:[1,1,1,1] row_mask:0xf bank_mask:0xf
    v_add_f32_dpp v63, v49, v63 quad_perm:[1,1,1,1] row_mask:0xf bank_mask:0xf
    v_add_f32_dpp v60, v38, v60 quad_perm:[2,2,2,2] row_mask:0xf bank_mask:0xf
    v_add_f32_dpp v61, v42, v61 quad_perm:[2,2,2,2] row_mask:0xf bank_mask:0xf
    v_add_f32_dpp v62, v46, v62 quad_perm:[2,2,2,2] row_mask:0xf bank_mask:0xf
    v_add_f32_dpp v63, v50, v63 quad_perm:[2,2,2,2] row_mask:0xf bank_mask:0xf
    v_add_f32_dpp v60, v39, v60 quad_perm:[3,3,3,3] row_mask:0xf bank_mask:0xf
    v_add_f32_dpp v61, v43, v61 quad_perm:[3,3,3,3] row_mask:0xf bank_mask:0xf
    v_add_f32_dpp v62, v47, v62 quad_perm:[3,3,3,3] row_mask:0xf bank_mask:0xf
    v_add_f32_dpp v63, v51, v63 quad_perm:[3,3,3,3] row_mask:0xf bank_mask:0xf
    v_mfma_f32_16x16x32_bf16 v[36:39], v[104:107], v[82:85], 0
    v_mfma_f32_16x16x32_bf16 v[40:43], v[108:111], v[82:85], 0
    v_mfma_f32_16x16x32_bf16 v[44:47], v[112:115], v[82:85], 0
    v_mfma_f32_16x16x32_bf16 v[48:51], v[116:119], v[82:85], 0
    s_nop 4
    v_mov_b32_dpp v64, v36 quad_perm:[0,0,0,0] row_mask:0xf bank_mask:0xf
    v_mov_b32_dpp v65, v40 quad_perm:[0,0,0,0] row_mask:0xf bank_mask:0xf
    v_mov_b32_dpp v66, v44 quad_perm:[0,0,0,0] row_mask:0xf bank_mask:0xf
    v_mov_b32_dpp v67, v48 quad_perm:[0,0,0,0] row_mask:0xf bank_mask:0xf
    v_add_f32_dpp v64, v37, v64 quad_perm:[1,1,1,1] row_mask:0xf bank_mask:0xf
    v_add_f32_dpp v65, v41, v65 quad_perm:[1,1,1,1] row_mask:0xf bank_mask:0xf
    v_add_f32_dpp v66, v45, v66 quad_perm:[1,1,1,1] row_mask:0xf bank_mask:0xf
    v_add_f32_dpp v67, v49, v67 quad_perm:[1,1,1,1] row_mask:0xf bank_mask:0xf
    v_add_f32_dpp v64, v38, v64 quad_perm:[2,2,2,2] row_mask:0xf bank_mask:0xf
    v_add_f32_dpp v65, v42, v65 quad_perm:[2,2,2,2] row_mask:0xf bank_mask:0xf
    v_add_f32_dpp v66, v46, v66 quad_perm:[2,2,2,2] row_mask:0xf bank_mask:0xf
    v_add_f32_dpp v67, v50, v67 quad_perm:[2,2,2,2] row_mask:0xf bank_mask:0xf
    v_add_f32_dpp v64, v39, v64 quad_perm:[3,3,3,3] row_mask:0xf bank_mask:0xf
    v_add_f32_dpp v65, v43, v65 quad_perm:[3,3,3,3] row_mask:0xf bank_mask:0xf
    v_add_f32_dpp v66, v47, v66 quad_perm:[3,3,3,3] row_mask:0xf bank_mask:0xf
    v_add_f32_dpp v67, v51, v67 quad_perm:[3,3,3,3] row_mask:0xf bank_mask:0xf
    s_waitcnt vmcnt(3)
    buffer_load_dwordx4 v[156:159], v8, s[48:51], s84 offen nt
    v_cvt_pk_bf16_f32 v36, v60, v61
    v_cvt_pk_bf16_f32 v38, v62, v63
    v_cvt_pk_bf16_f32 v40, v64, v65
    v_cvt_pk_bf16_f32 v42, v66, v67
    v_lshlrev_b32 v60, 16, v36
    v_and_b32 v61, 0xffff0000, v36
    v_lshlrev_b32 v62, 16, v38
    v_and_b32 v63, 0xffff0000, v38
    v_lshlrev_b32 v64, 16, v40
    v_and_b32 v65, 0xffff0000, v40
    v_lshlrev_b32 v66, 16, v42
    v_and_b32 v67, 0xffff0000, v42
    v_mul_f32 v60, s77, v60
    v_mul_f32 v61, s77, v61
    v_mul_f32 v62, s77, v62
    v_mul_f32 v63, s77, v63
    v_mul_f32 v64, s77, v64
    v_mul_f32 v65, s77, v65
    v_mul_f32 v66, s77, v66
    v_mul_f32 v67, s77, v67
    v_cvt_pk_bf16_f32 v36, v60, v61
    v_cvt_pk_bf16_f32 v38, v62, v63
    v_cvt_pk_bf16_f32 v40, v64, v65
    v_cvt_pk_bf16_f32 v42, v66, v67
    v_lshlrev_b32 v60, 16, v36
    v_and_b32 v61, 0xffff0000, v36
    v_lshlrev_b32 v62, 16, v38
    v_and_b32 v63, 0xffff0000, v38
    v_lshlrev_b32 v64, 16, v40
    v_and_b32 v65, 0xffff0000, v40
    v_lshlrev_b32 v66, 16, v42
    v_and_b32 v67, 0xffff0000, v42
    v_max3_f32 v86, v60, v61, v62
    v_max3_f32 v78, v63, v64, v65
    v_max3_f32 v86, v86, v66, v67
    v_max_f32 v86, v86, v78
    v_mov_b32 v78, v86
    s_nop 1
    v_permlane16_swap_b32 v86, v78
    v_max_f32 v86, v86, v78
    v_mov_b32 v78, v86
    s_nop 1
    v_permlane32_swap_b32 v86, v78
    v_max_f32 v86, v86, v78
    s_waitcnt vmcnt(3)
    s_add_u32 s84, s84, 73728
    buffer_load_dwordx4 v[160:163], v8, s[48:51], s84 offen nt
    v_mul_f32 v78, s78, v86
    v_fma_f32 v60, v60, s78, -v78
    v_fma_f32 v61, v61, s78, -v78
    v_fma_f32 v62, v62, s78, -v78
    v_fma_f32 v63, v63, s78, -v78
    v_fma_f32 v64, v64, s78, -v78
    v_fma_f32 v65, v65, s78, -v78
    v_fma_f32 v66, v66, s78, -v78
    v_fma_f32 v67, v67, s78, -v78
    v_exp_f32 v60, v60
    v_exp_f32 v61, v61
    v_exp_f32 v62, v62
    v_exp_f32 v63, v63
    v_exp_f32 v64, v64
    v_exp_f32 v65, v65
    v_exp_f32 v66, v66
    v_exp_f32 v67, v67
    v_add_f32 v87, v60, v61
    v_add_f32 v78, v62, v63
    v_add_f32 v79, v64, v65
    v_add_f32 v80, v66, v67
    v_cvt_pk_bf16_f32 v60, v60, v60
    v_cvt_pk_bf16_f32 v61, v61, v61
    v_cvt_pk_bf16_f32 v62, v62, v62
    v_cvt_pk_bf16_f32 v63, v63, v63
    v_cvt_pk_bf16_f32 v64, v64, v64
    v_cvt_pk_bf16_f32 v65, v65, v65
    v_cvt_pk_bf16_f32 v66, v66, v66
    v_cvt_pk_bf16_f32 v67, v67, v67
    v_add_f32 v87, v87, v78
    v_add_f32 v79, v79, v80
    v_add_f32 v87, v87, v79
    v_and_b32 v88, v60, v12
    v_and_b32 v89, v60, v13
    v_and_b32 v90, v60, v14
    v_and_b32 v91, v60, v15
    s_nop 1
    v_mfma_f32_16x16x32_bf16 v[28:31], v[120:123], v[88:91], 0
    v_and_b32 v92, v61, v12
    v_and_b32 v93, v61, v13
    v_and_b32 v94, v61, v14
    v_and_b32 v95, v61, v15
    s_nop 1
    v_mfma_f32_16x16x32_bf16 v[28:31], v[124:127], v[92:95], v[28:31]
    v_and_b32 v96, v62, v12
    v_and_b32 v97, v62, v13
    v_and_b32 v98, v62, v14
    v_and_b32 v99, v62, v15
    s_nop 1
    v_mfma_f32_16x16x32_bf16 v[28:31], v[128:131], v[96:99], v[28:31]
    v_and_b32 v100, v63, v12
    v_and_b32 v101, v63, v13
    v_and_b32 v102, v63, v14
    v_and_b32 v103, v63, v15
    s_nop 1
    v_mfma_f32_16x16x32_bf16 v[28:31], v[132:135], v[100:103], v[28:31]
    v_and_b32 v104, v64, v12
    v_and_b32 v105, v64, v13
    v_and_b32 v106, v64, v14
    v_and_b32 v107, v64, v15
    s_nop 1
    v_mfma_f32_16x16x32_bf16 v[28:31], v[136:139], v[104:107], v[28:31]
    v_and_b32 v108, v65, v12
    v_and_b32 v109, v65, v13
    v_and_b32 v110, v65, v14
    v_and_b32 v111, v65, v15
    s_nop 1
    v_mfma_f32_16x16x32_bf16 v[28:31], v[140:143], v[108:111], v[28:31]
    v_and_b32 v112, v66, v12
    v_and_b32 v113, v66, v13
    v_and_b32 v114, v66, v14
    v_and_b32 v115, v66, v15
    s_nop 1
    v_mfma_f32_16x16x32_bf16 v[28:31], v[144:147], v[112:115], v[28:31]
    v_and_b32 v116, v67, v12
    v_and_b32 v117, v67, v13
    v_and_b32 v118, v67, v14
    v_and_b32 v119, v67, v15
    v_mov_b32 v78, v87
    s_nop 1
    v_permlane16_swap_b32 v87, v78
    v_add_f32 v87, v87, v78
    v_mov_b32 v78, v87
    s_nop 1
    v_permlane32_swap_b32 v87, v78
    v_add_f32 v87, v87, v78
    v_lshrrev_b32 v78, 3, v3
    v_lshlrev_b32 v78, 3, v78
    v_lshl_add_u32 v78, v2, 4, v78
    ds_write_b64 v78, v[86:87] offset:5632
    ds_read2_b32 v[36:37], v18 offset0:40 offset1:44
    ds_read2_b32 v[38:39], v18 offset0:0 offset1:4
    ds_read2_b32 v[40:41], v18 offset0:8 offset1:12
    ds_read2_b32 v[42:43], v18 offset0:16 offset1:20
    ds_read2_b32 v[44:45], v18 offset0:24 offset1:28
    ds_read2_b32 v[46:47], v18 offset0:32 offset1:36
    s_waitcnt vmcnt(3)
    s_add_u32 s84, s84, 73728
    buffer_load_dwordx4 v[164:167], v8, s[48:51], s84 offen nt
    v_mfma_f32_16x16x32_bf16 v[28:31], v[148:151], v[116:119], v[28:31]
    v_lshlrev_b32 v81, 4, v0
    s_nop 6
    ds_write_b128 v81, v[28:31] offset:24576
    s_waitcnt lgkmcnt(0)
    s_barrier
    v_and_b32 v36, s52, v36
    v_and_b32 v37, s52, v37
    s_waitcnt vmcnt(3)
    s_add_u32 s84, s84, 73728
    buffer_load_dwordx4 v[120:123], v8, s[48:51], s84 offen nt
    v_and_b32 v20, v36, v12
    v_and_b32 v21, v36, v13
    v_and_b32 v22, v36, v14
    v_and_b32 v23, v36, v15
    s_nop 1
    v_mfma_f32_16x16x32_bf16 v[32:35], v[152:155], v[20:23], 0
    v_and_b32 v24, v37, v12
    v_and_b32 v25, v37, v13
    v_and_b32 v26, v37, v14
    v_and_b32 v27, v37, v15
    s_nop 1
    v_mfma_f32_16x16x32_bf16 v[28:31], v[152:155], v[24:27], 0
    s_waitcnt vmcnt(3)
    s_add_u32 s84, s84, 73728
    buffer_load_dwordx4 v[124:127], v8, s[48:51], s84 offen nt
    v_and_b32 v20, v38, v12
    v_and_b32 v21, v38, v13
    v_and_b32 v22, v38, v14
    v_and_b32 v23, v38, v15
    s_nop 1
    v_mfma_f32_16x16x32_bf16 v[32:35], v[156:159], v[20:23], v[32:35]
    v_and_b32 v24, v39, v12
    v_and_b32 v25, v39, v13
    v_and_b32 v26, v39, v14
    v_and_b32 v27, v39, v15
    s_nop 1
    v_mfma_f32_16x16x32_bf16 v[28:31], v[156:159], v[24:27], v[28:31]
    s_waitcnt vmcnt(3)
    buffer_load_dwordx4 v[88:91], v9, s[20:23], s85 offen nt
    v_and_b32 v20, v40, v12
    v_and_b32 v21, v40, v13
    v_and_b32 v22, v40, v14
    v_and_b32 v23, v40, v15
    s_nop 1
    v_mfma_f32_16x16x32_bf16 v[32:35], v[160:163], v[20:23], v[32:35]
    v_and_b32 v24, v41, v12
    v_and_b32 v25, v41, v13
    v_and_b32 v26, v41, v14
    v_and_b32 v27, v41, v15
    s_nop 1
    v_mfma_f32_16x16x32_bf16 v[28:31], v[160:163], v[24:27], v[28:31]
    s_waitcnt vmcnt(3)
    s_add_u32 s85, s85, 36864
    buffer_load_dwordx4 v[92:95], v9, s[20:23], s85 offen nt
    v_and_b32 v20, v42, v12
    v_and_b32 v21, v42, v13
    v_and_b32 v22, v42, v14
    v_and_b32 v23, v42, v15
    s_nop 1
    v_mfma_f32_16x16x32_bf16 v[32:35], v[164:167], v[20:23], v[32:35]
    v_and_b32 v24, v43, v12
    v_and_b32 v25, v43, v13
    v_and_b32 v26, v43, v14
    v_and_b32 v27, v43, v15
    s_nop 1
    v_mfma_f32_16x16x32_bf16 v[28:31], v[164:167], v[24:27], v[28:31]
    s_waitcnt vmcnt(3)
    s_add_u32 s85, s85, 36864
    buffer_load_dwordx4 v[96:99], v9, s[20:23], s85 offen nt
    v_and_b32 v20, v44, v12
    v_and_b32 v21, v44, v13
    v_and_b32 v22, v44, v14
    v_and_b32 v23, v44, v15
    s_nop 1
    v_mfma_f32_16x16x32_bf16 v[32:35], v[120:123], v[20:23], v[32:35]
    v_and_b32 v24, v45, v12
    v_and_b32 v25, v45, v13
    v_and_b32 v26, v45, v14
    v_and_b32 v27, v45, v15
    s_nop 1
    v_mfma_f32_16x16x32_bf16 v[28:31], v[120:123], v[24:27], v[28:31]
    s_waitcnt vmcnt(3)
    s_add_u32 s85, s85, 36864
    buffer_load_dwordx4 v[100:103], v9, s[20:23], s85 offen nt
    v_and_b32 v20, v46, v12
    v_and_b32 v21, v46, v13
    v_and_b32 v22, v46, v14
    v_and_b32 v23, v46, v15
    s_nop 1
    v_mfma_f32_16x16x32_bf16 v[32:35], v[124:127], v[20:23], v[32:35]
    v_and_b32 v24, v47, v12
    v_and_b32 v25, v47, v13
    v_and_b32 v26, v47, v14
    v_and_b32 v27, v47, v15
    s_nop 1
    v_mfma_f32_16x16x32_bf16 v[28:31], v[124:127], v[24:27], v[28:31]
    v_cmp_gt_u32 vcc, 32, v1
    v_lshlrev_b32 v81, 4, v0
    s_nop 5
    v_cndmask_b32 v32, v28, v32, vcc
    v_cndmask_b32 v33, v29, v33, vcc
    v_cndmask_b32 v34, v30, v34, vcc
    v_cndmask_b32 v35, v31, v35, vcc
    ds_write_b128 v81, v[32:35] offset:32768
    s_mul_i32 s66, s2, 4608
    s_add_u32 s66, s66, 1310720
    s_waitcnt lgkmcnt(0)
    s_barrier
    s_barrier
    s_waitcnt vmcnt(2)
    s_barrier
    s_barrier
    s_add_u32 s67, s55, 0
    s_lshr_b32 s68, s67, 3
    s_lshl_b32 s68, s68, 5
    s_and_b32 s67, s67, 7
    s_add_u32 s67, s67, s68
    s_mul_i32 s67, s67, 1152
    s_add_u32 s67, s67, s86
    buffer_load_dwordx4 v[104:107], v9, s[32:35], s67 offen nt
    s_add_u32 s67, s55, 1
    s_lshr_b32 s68, s67, 3
    s_lshl_b32 s68, s68, 5
    s_and_b32 s67, s67, 7
    s_add_u32 s67, s67, s68
    s_mul_i32 s67, s67, 1152
    s_add_u32 s67, s67, s86
    buffer_load_dwordx4 v[108:111], v9, s[32:35], s67 offen nt
    s_add_u32 s67, s55, 2
    s_lshr_b32 s68, s67, 3
    s_lshl_b32 s68, s68, 5
    s_and_b32 s67, s67, 7
    s_add_u32 s67, s67, s68
    s_mul_i32 s67, s67, 1152
    s_add_u32 s67, s67, s86
    buffer_load_dwordx4 v[112:115], v9, s[32:35], s67 offen nt
    s_add_u32 s67, s55, 3
    s_lshr_b32 s68, s67, 3
    s_lshl_b32 s68, s68, 5
    s_and_b32 s67, s67, 7
    s_add_u32 s67, s67, s68
    s_mul_i32 s67, s67, 1152
    s_add_u32 s67, s67, s86
    buffer_load_dwordx4 v[116:119], v9, s[32:35], s67 offen nt
    s_add_u32 s67, s55, 4
    s_lshr_b32 s68, s67, 3
    s_lshl_b32 s68, s68, 5
    s_and_b32 s67, s67, 7
    s_add_u32 s67, s67, s68
    s_mul_i32 s67, s67, 1152
    s_add_u32 s67, s67, s86
    s_add_u32 s67, s67, s54
    buffer_load_dwordx4 v[152:155], v9, s[32:35], s67 offen nt
    v_cmp_gt_u32 vcc, 288, v0
    s_mov_b64 s[88:89], vcc
    s_barrier
    ds_read2_b32 v[68:69], v19 offset0:0 offset1:4
    ds_read2_b32 v[70:71], v19 offset0:8 offset1:12
    ds_read2_b32 v[72:73], v19 offset0:16 offset1:20
    ds_read2_b32 v[74:75], v19 offset0:24 offset1:28
    ds_read_b32 v76, v19 offset:128
    s_waitcnt lgkmcnt(4)
    v_and_b32 v20, v68, v12
    v_and_b32 v21, v68, v13
    v_and_b32 v22, v68, v14
    v_and_b32 v23, v68, v15
    s_waitcnt vmcnt(8)
    s_nop 0
    v_mfma_f32_16x16x32_bf16 v[36:39], v[88:91], v[20:23], 0
    v_and_b32 v24, v69, v12
    v_and_b32 v25, v69, v13
    v_and_b32 v26, v69, v14
    v_and_b32 v27, v69, v15
    s_waitcnt vmcnt(7)
    s_nop 0
    v_mfma_f32_16x16x32_bf16 v[36:39], v[92:95], v[24:27], v[36:39]
    s_waitcnt lgkmcnt(3)
    v_and_b32 v20, v70, v12
    v_and_b32 v21, v70, v13
    v_and_b32 v22, v70, v14
    v_and_b32 v23, v70, v15
    s_waitcnt vmcnt(6)
    s_nop 0
    v_mfma_f32_16x16x32_bf16 v[36:39], v[96:99], v[20:23], v[36:39]
    v_and_b32 v24, v71, v12
    v_and_b32 v25, v71, v13
    v_and_b32 v26, v71, v14
    v_and_b32 v27, v71, v15
    s_waitcnt vmcnt(5)
    s_nop 0
    v_mfma_f32_16x16x32_bf16 v[36:39], v[100:103], v[24:27], v[36:39]
    s_waitcnt lgkmcnt(2)
    v_and_b32 v20, v72, v12
    v_and_b32 v21, v72, v13
    v_and_b32 v22, v72, v14
    v_and_b32 v23, v72, v15
    s_waitcnt vmcnt(4)
    s_nop 0
    v_mfma_f32_16x16x32_bf16 v[36:39], v[104:107], v[20:23], v[36:39]
    v_and_b32 v24, v73, v12
    v_and_b32 v25, v73, v13
    v_and_b32 v26, v73, v14
    v_and_b32 v27, v73, v15
    s_waitcnt vmcnt(3)
    s_nop 0
    v_mfma_f32_16x16x32_bf16 v[36:39], v[108:111], v[24:27], v[36:39]
    s_waitcnt lgkmcnt(1)
    v_and_b32 v20, v74, v12
    v_and_b32 v21, v74, v13
    v_and_b32 v22, v74, v14
    v_and_b32 v23, v74, v15
    s_waitcnt vmcnt(2)
    s_nop 0
    v_mfma_f32_16x16x32_bf16 v[36:39], v[112:115], v[20:23], v[36:39]
    v_and_b32 v24, v75, v12
    v_and_b32 v25, v75, v13
    v_and_b32 v26, v75, v14
    v_and_b32 v27, v75, v15
    s_waitcnt vmcnt(1)
    s_nop 0
    v_mfma_f32_16x16x32_bf16 v[36:39], v[116:119], v[24:27], v[36:39]
    s_waitcnt lgkmcnt(0)
    v_and_b32 v20, v76, v12
    v_and_b32 v21, v76, v13
    v_and_b32 v22, v76, v14
    v_and_b32 v23, v76, v15
    s_waitcnt vmcnt(0)
    s_nop 0
    v_mfma_f32_16x16x32_bf16 v[36:39], v[152:155], v[20:23], v[36:39]
    s_nop 7
    s_cmp_lt_u32 s56, 5
    s_cbranch_scc0 SKIP_39
    s_mov_b64 exec, s[88:89]
    v_bfi_b32 v36, v16, s71, v36
    v_bfi_b32 v37, v16, s72, v37
    v_bfi_b32 v38, v16, s73, v38
    v_bfi_b32 v39, v16, s74, v39
    buffer_store_dwordx4 v[36:39], v81, s[40:43], s66 offen sc1
    s_mov_b64 exec, -1
SKIP_39:
    s_nop 0
    s_cmp_ge_u32 s2, 36
    s_cbranch_scc1 FIN
    v_lshrrev_b32 v78, 3, v0
    v_mul_u32_u24 v78, 4608, v78
    v_and_b32 v79, 7, v0
    v_lshl_add_u32 v78, v79, 4, v78
    s_lshl_b32 s67, s2, 7
    s_add_u32 s67, s67, 1310720
    s_add_u32 s81, s67, 294912
    s_add_u32 s82, s67, 589824
    s_add_u32 s83, s67, 884736
    s_lshr_b32 s68, s2, 3
    s_lshl_b32 s68, s68, 7
    s_bfe_u32 s69, s2, 0x20001
    s_lshl_b32 s69, s69, 5
    s_add_u32 s68, s68, s69
    s_and_b32 s69, s2, 1
    s_mul_i32 s69, s69, 576
    s_add_u32 s68, s68, s69
    s_lshl_b32 s84, s68, 1
    v_lshlrev_b32 v80, 1, v0
    v_mov_b32 v81, 1073741824
    v_cmp_gt_u32 vcc, 32, v0
    s_nop 1
    v_cndmask_b32 v80, v81, v80, vcc
    buffer_load_ushort v85, v80, s[4:7], s84 offen
    v_lshlrev_b32 v82, 7, v2
    v_lshl_add_u32 v82, v79, 4, v82
    v_bfe_u32 v83, v1, 3, 2
    v_lshlrev_b32 v83, 2, v83
    v_lshl_add_u32 v83, v79, 4, v83
    v_cmp_gt_u32 s[8:9], 8, v1
    s_mov_b64 s[88:89], -1
    s_mov_b64 s[90:91], -1
    s_mov_b64 s[92:93], -1
    s_mov_b64 s[94:95], -1
    s_mov_b32 s80, 0
    s_or_b64 exec, s[88:89], 1
    buffer_load_dwordx4 v[88:91], v78, s[40:43], s67 offen sc1
    s_or_b64 exec, s[90:91], 1
    buffer_load_dwordx4 v[92:95], v78, s[40:43], s81 offen sc1
    s_or_b64 exec, s[92:93], 1
    buffer_load_dwordx4 v[96:99], v78, s[40:43], s82 offen sc1
    s_or_b64 exec, s[94:95], 1
    buffer_load_dwordx4 v[100:103], v78, s[40:43], s83 offen sc1
FG_TRY_40:
    s_or_b64 exec, s[88:89], 1
    buffer_load_dwordx4 v[88:91], v78, s[40:43], s67 offen sc1
    s_or_b64 exec, s[90:91], 1
    buffer_load_dwordx4 v[92:95], v78, s[40:43], s81 offen sc1
    s_or_b64 exec, s[92:93], 1
    buffer_load_dwordx4 v[96:99], v78, s[40:43], s82 offen sc1
    s_or_b64 exec, s[94:95], 1
    buffer_load_dwordx4 v[100:103], v78, s[40:43], s83 offen sc1
    s_waitcnt vmcnt(4)
    s_or_b64 exec, s[88:89], 1
    v_perm_b32 v86, v89, v88, s75
    v_perm_b32 v87, v91, v90, s76
    v_or_b32 v86, v86, v87
    v_cmp_ne_u32 s[88:89], s70, v86
    s_or_b64 exec, s[90:91], 1
    v_perm_b32 v86, v93, v92, s75
    v_perm_b32 v87, v95, v94, s76
    v_or_b32 v86, v86, v87
    v_cmp_ne_u32 s[90:91], s70, v86
    s_or_b64 exec, s[92:93], 1
    v_perm_b32 v86, v97, v96, s75
    v_perm_b32 v87, v99, v98, s76
    v_or_b32 v86, v86, v87
    v_cmp_ne_u32 s[92:93], s70, v86
    s_or_b64 exec, s[94:95], 1
    v_perm_b32 v86, v101, v100, s75
    v_perm_b32 v87, v103, v102, s76
    v_or_b32 v86, v86, v87
    v_cmp_ne_u32 s[94:95], s70, v86
    s_mov_b64 exec, -1
    s_or_b64 vcc, s[88:89], s[90:91]
    s_or_b64 s[12:13], s[92:93], s[94:95]
    s_or_b64 vcc, vcc, s[12:13]
    s_cmp_eq_u64 vcc, 0
    s_cbranch_scc1 FG_OK_41
    s_add_u32 s80, s80, 1
    s_cmp_le_u32 s80, 32768
    s_cbranch_scc1 FG_TRY_40
FG_OK_41:
    v_and_b32 v120, s87, v88
    v_and_b32 v121, s87, v89
    v_and_b32 v122, s87, v90
    v_and_b32 v123, s87, v91
    v_and_b32 v124, s87, v92
    v_and_b32 v125, s87, v93
    v_and_b32 v126, s87, v94
    v_and_b32 v127, s87, v95
    v_and_b32 v128, s87, v96
    v_and_b32 v129, s87, v97
    v_and_b32 v130, s87, v98
    v_and_b32 v131, s87, v99
    v_and_b32 v132, s87, v100
    v_and_b32 v133, s87, v101
    v_and_b32 v134, s87, v102
    v_and_b32 v135, s87, v103
    v_add_f32 v120, v120, v124
    v_add_f32 v128, v128, v132
    v_add_f32 v121, v121, v125
    v_add_f32 v129, v129, v133
    v_add_f32 v122, v122, v126
    v_add_f32 v130, v130, v134
    v_add_f32 v123, v123, v127
    v_add_f32 v131, v131, v135
    v_add_f32 v120, v120, v128
    v_add_f32 v121, v121, v129
    v_add_f32 v122, v122, v130
    v_add_f32 v123, v123, v131
    v_add_f32_dpp v120, v120, v120 row_ror:8 row_mask:0xf bank_mask:0xf
    v_add_f32_dpp v121, v121, v121 row_ror:8 row_mask:0xf bank_mask:0xf
    v_add_f32_dpp v122, v122, v122 row_ror:8 row_mask:0xf bank_mask:0xf
    v_add_f32_dpp v123, v123, v123 row_ror:8 row_mask:0xf bank_mask:0xf
    v_mov_b32 v124, v120
    v_mov_b32 v125, v121
    v_mov_b32 v126, v122
    v_mov_b32 v127, v123
    v_permlane16_swap_b32 v120, v124
    v_permlane16_swap_b32 v121, v125
    v_permlane16_swap_b32 v122, v126
    v_permlane16_swap_b32 v123, v127
    v_add_f32 v120, v120, v124
    v_add_f32 v121, v121, v125
    v_add_f32 v122, v122, v126
    v_add_f32 v123, v123, v127
    v_mov_b32 v124, v120
    v_mov_b32 v125, v121
    v_mov_b32 v126, v122
    v_mov_b32 v127, v123
    v_permlane32_swap_b32 v120, v124
    v_permlane32_swap_b32 v121, v125
    v_permlane32_swap_b32 v122, v126
    v_permlane32_swap_b32 v123, v127
    v_add_f32 v120, v120, v124
    v_add_f32 v121, v121, v125
    v_add_f32 v122, v122, v126
    v_add_f32 v123, v123, v127
    s_mov_b64 exec, s[8:9]
    ds_write_b128 v82, v[120:123] offset:6144
    s_mov_b64 exec, -1
    v_lshlrev_b32 v85, 16, v85
    s_waitcnt lgkmcnt(0)
    s_barrier
    s_cmp_eq_u32 s56, 0
    s_cbranch_scc0 SKIP_42
    ds_read_b32 v120, v83 offset:6144
    ds_read_b32 v121, v83 offset:6272
    ds_read_b32 v122, v83 offset:6400
    ds_read_b32 v123, v83 offset:6528
    ds_read_b32 v124, v83 offset:6656
    ds_read_b32 v125, v83 offset:6784
    ds_read_b32 v126, v83 offset:6912
    ds_read_b32 v127, v83 offset:7040
    s_waitcnt lgkmcnt(4)
    v_add_f32 v120, v120, v121
    v_add_f32 v122, v122, v123
    v_add_f32 v120, v120, v85
    s_waitcnt lgkmcnt(0)
    v_add_f32 v124, v124, v125
    v_add_f32 v126, v126, v127
    v_add_f32 v120, v120, v122
    v_add_f32 v124, v124, v126
    v_add_f32 v120, v120, v124
    v_cvt_pk_bf16_f32 v120, v120, v120
    buffer_store_short v120, v80, s[36:39], s84 offen
NOEP_43:
SKIP_42:
    s_nop 0
    s_cmp_eq_u32 s56, 1
    s_cbranch_scc0 SKIP_44
    s_cmp_eq_u32 s2, 0
    s_cbranch_scc0 SKIP_44
    s_add_u32 s79, s79, 1
    v_mov_b32 v84, s79
    v_mov_b32 v86, 0
    v_cmp_eq_u32 vcc, 0, v1
    s_and_saveexec_b64 s[88:89], vcc
    buffer_store_dword v84, v86, s[40:43], 0 offen
    s_mov_b64 exec, s[88:89]
SKIP_44:
FIN_S:
FIN:
FIN2:
END:
    s_endpgm
SERVICE:
    s_setprio 2
    v_mov_b32 v152, 0
    v_mov_b32 v154, 0
    v_mov_b32 v155, 0
    v_mov_b32 v124, 0
    v_lshlrev_b32 v78, 1, v1
    s_mul_i32 s68, s56, 1152
    s_waitcnt lgkmcnt(0)
    s_load_dword s79, s[40:41], 0
    s_cmp_lt_u32 s56, 2
    s_cbranch_scc0 SKIP_1
    buffer_load_ushort v88, v78, s[4:7], s68 offen offset:0
    buffer_load_ushort v89, v78, s[4:7], s68 offen offset:128
    buffer_load_ushort v90, v78, s[4:7], s68 offen offset:256
    buffer_load_ushort v91, v78, s[4:7], s68 offen offset:384
    buffer_load_ushort v92, v78, s[4:7], s68 offen offset:512
    buffer_load_ushort v93, v78, s[4:7], s68 offen offset:640
    buffer_load_ushort v94, v78, s[4:7], s68 offen offset:768
    buffer_load_ushort v95, v78, s[4:7], s68 offen offset:896
    buffer_load_ushort v96, v78, s[4:7], s68 offen offset:1024
SKIP_1:
    s_barrier
    s_barrier
    s_barrier
    s_cmp_lt_u32 s56, 2
    s_cbranch_scc0 SKIP_2
    s_waitcnt vmcnt(0)
    v_lshlrev_b32 v88, 16, v88
    v_lshlrev_b32 v89, 16, v89
    v_lshlrev_b32 v90, 16, v90
    v_lshlrev_b32 v91, 16, v91
    v_lshlrev_b32 v92, 16, v92
    v_lshlrev_b32 v93, 16, v93
    v_lshlrev_b32 v94, 16, v94
    v_lshlrev_b32 v95, 16, v95
    v_lshlrev_b32 v96, 16, v96
    v_add_f32 v79, v88, v89
    v_add_f32 v81, v90, v91
    v_add_f32 v82, v92, v93
    v_add_f32 v83, v94, v95
    v_add_f32 v79, v79, v81
    v_add_f32 v82, v82, v83
    v_add_f32 v79, v79, v96
    v_add_f32 v79, v79, v82
    s_nop 1
    v_add_f32_dpp v79, v79, v79 quad_perm:[1,0,3,2] row_mask:0xf bank_mask:0xf
    s_nop 1
    v_add_f32_dpp v79, v79, v79 quad_perm:[2,3,0,1] row_mask:0xf bank_mask:0xf
    s_nop 1
    v_add_f32_dpp v79, v79, v79 row_half_mirror row_mask:0xf bank_mask:0xf
    s_nop 1
    v_add_f32_dpp v79, v79, v79 row_mirror row_mask:0xf bank_mask:0xf
    v_mov_b32 v80, v79
    s_nop 1
    v_permlane16_swap_b32 v79, v80
    v_add_f32 v79, v79, v80
    v_mov_b32 v80, v79
    s_nop 1
    v_permlane32_swap_b32 v79, v80
    v_add_f32 v79, v79, v80
    v_mul_f32 v79, 0x3ae38e39, v79
    v_sub_f32 v104, v88, v79
    v_sub_f32 v105, v89, v79
    v_sub_f32 v106, v90, v79
    v_sub_f32 v107, v91, v79
    v_sub_f32 v108, v92, v79
    v_sub_f32 v109, v93, v79
    v_sub_f32 v110, v94, v79
    v_sub_f32 v111, v95, v79
    v_sub_f32 v112, v96, v79
    v_mul_f32 v82, v104, v104
    v_mul_f32 v83, v105, v105
    v_fmac_f32 v82, v106, v106
    v_fmac_f32 v83, v107, v107
    v_fmac_f32 v82, v108, v108
    v_fmac_f32 v83, v109, v109
    v_fmac_f32 v82, v110, v110
    v_fmac_f32 v83, v111, v111
    v_fmac_f32 v82, v112, v112
    v_add_f32 v82, v82, v83
    v_cvt_pk_bf16_f32 v79, v79, v79
    v_and_b32 v79, 0xffff0000, v79
    v_sub_f32 v88, v88, v79
    v_sub_f32 v89, v89, v79
    v_sub_f32 v90, v90, v79
    v_sub_f32 v91, v91, v79
    v_sub_f32 v92, v92, v79
    v_sub_f32 v93, v93, v79
    v_sub_f32 v94, v94, v79
    v_sub_f32 v95, v95, v79
    v_sub_f32 v96, v96, v79
    v_add_f32_dpp v82, v82, v82 quad_perm:[1,0,3,2] row_mask:0xf bank_mask:0xf
    s_nop 1
    v_add_f32_dpp v82, v82, v82 quad_perm:[2,3,0,1] row_mask:0xf bank_mask:0xf
    s_nop 1
    v_add_f32_dpp v82, v82, v82 row_half_mirror row_mask:0xf bank_mask:0xf
    s_nop 1
    v_add_f32_dpp v82, v82, v82 row_mirror row_mask:0xf bank_mask:0xf
    v_mov_b32 v80, v82
    s_nop 1
    v_permlane16_swap_b32 v82, v80
    v_add_f32 v82, v82, v80
    v_mov_b32 v80, v82
    s_nop 1
    v_permlane32_swap_b32 v82, v80
    v_add_f32 v82, v82, v80
    v_mul_f32 v82, 0x3ae38e39, v82
    v_cvt_pk_bf16_f32 v82, v82, v82
    v_and_b32 v82, 0xffff0000, v82
    v_add_f32 v82, 0x3727c5ac, v82
    v_cvt_pk_bf16_f32 v82, v82, v82
    v_and_b32 v82, 0xffff0000, v82
    v_sqrt_f32 v82, v82
    v_cvt_pk_bf16_f32 v88, v88, v88
    v_cvt_pk_bf16_f32 v89, v89, v89
    v_cvt_pk_bf16_f32 v90, v90, v90
    v_cvt_pk_bf16_f32 v91, v91, v91
    v_cvt_pk_bf16_f32 v92, v92, v92
    v_cvt_pk_bf16_f32 v93, v93, v93
    v_cvt_pk_bf16_f32 v94, v94, v94
    v_cvt_pk_bf16_f32 v95, v95, v95
    v_cvt_pk_bf16_f32 v96, v96, v96
    v_cvt_pk_bf16_f32 v82, v82, v82
    v_and_b32 v82, 0xffff0000, v82
    v_rcp_f32 v83, v82
    v_and_b32 v88, 0xffff0000, v88
    v_and_b32 v89, 0xffff0000, v89
    v_and_b32 v90, 0xffff0000, v90
    v_and_b32 v91, 0xffff0000, v91
    v_and_b32 v92, 0xffff0000, v92
    v_and_b32 v93, 0xffff0000, v93
    v_and_b32 v94, 0xffff0000, v94
    v_and_b32 v95, 0xffff0000, v95
    v_and_b32 v96, 0xffff0000, v96
    s_mul_i32 s67, s56, 2304
    v_lshlrev_b32 v84, 2, v1
    v_add_u32 v84, s67, v84
    v_mul_f32 v88, v88, v83
    v_mul_f32 v89, v89, v83
    v_mul_f32 v90, v90, v83
    v_mul_f32 v91, v91, v83
    v_mul_f32 v92, v92, v83
    v_mul_f32 v93, v93, v83
    v_mul_f32 v94, v94, v83
    v_mul_f32 v95, v95, v83
    v_mul_f32 v96, v96, v83
    v_cvt_pk_bf16_f32 v88, v88, v88
    ds_write_b32 v84, v88 offset:0
    v_cvt_pk_bf16_f32 v89, v89, v89
    ds_write_b32 v84, v89 offset:256
    v_cvt_pk_bf16_f32 v90, v90, v90
    ds_write_b32 v84, v90 offset:512
    v_cvt_pk_bf16_f32 v91, v91, v91
    ds_write_b32 v84, v91 offset:768
    v_cvt_pk_bf16_f32 v92, v92, v92
    ds_write_b32 v84, v92 offset:1024
    v_cvt_pk_bf16_f32 v93, v93, v93
    ds_write_b32 v84, v93 offset:1280
    v_cvt_pk_bf16_f32 v94, v94, v94
    ds_write_b32 v84, v94 offset:1536
    v_cvt_pk_bf16_f32 v95, v95, v95
    ds_write_b32 v84, v95 offset:1792
    v_cvt_pk_bf16_f32 v96, v96, v96
    ds_write_b32 v84, v96 offset:2048
    s_waitcnt lgkmcnt(0)
SKIP_2:
    s_cmp_eq_u32 s56, 2
    s_cbranch_scc0 SKIP_3
    v_lshlrev_b32 v86, 2, v1
    v_mov_b32 v87, 0
    v_cmp_gt_u32 vcc, 8, v1
    s_and_saveexec_b64 s[88:89], vcc
    ds_write_b32 v86, v87 offset:5760
    s_mov_b64 exec, s[88:89]
    s_waitcnt lgkmcnt(0)
SKIP_3:
    s_barrier
    s_cmp_eq_u32 s56, 3
    s_cbranch_scc0 SKIP_4
    s_waitcnt lgkmcnt(0)
    s_mul_i32 s70, s79, 0x9E3779B1
    s_add_u32 s70, s70, 0x7F4A7C15
    s_bfe_u32 s71, s70, 0x80000
    s_bfe_u32 s72, s70, 0x80008
    s_bfe_u32 s73, s70, 0x80010
    s_bfe_u32 s74, s70, 0x80018
    s_getreg_b32 s64, hwreg(HW_REG_XCC_ID, 0, 4)
    s_lshl_b32 s67, s64, 8
    v_mov_b32 v120, s67
    v_mov_b32 v121, s67
    v_mov_b32 v122, s67
    v_mov_b32 v123, s67
    v_bfi_b32 v120, v16, s71, v120
    v_bfi_b32 v121, v16, s72, v121
    v_bfi_b32 v122, v16, s73, v122
    v_bfi_b32 v123, v16, s74, v123
    s_lshl_b32 s65, s57, 9
    s_add_u32 s65, s65, 3145728
    s_lshl_b32 s68, s58, 4
    v_mov_b32 v124, s68
    v_cmp_eq_u32 vcc, 0, v1
    s_and_saveexec_b64 s[88:89], vcc
    buffer_store_dwordx4 v[120:123], v124, s[40:43], s65 offen
    s_mov_b64 exec, s[88:89]
SKIP_4:
    v_lshrrev_b32 v78, 5, v1
    v_lshlrev_b32 v78, 13, v78
    v_bfe_u32 v79, v1, 3, 2
    v_lshl_add_u32 v78, v79, 8, v78
    v_and_b32 v80, 7, v1
    v_lshl_add_u32 v78, v80, 4, v78
    v_lshrrev_b32 v81, 5, v1
    v_lshlrev_b32 v81, 8, v81
    v_lshl_add_u32 v81, v79, 6, v81
    v_lshl_add_u32 v81, v80, 1, v81
    s_barrier
    s_waitcnt vmcnt(0) lgkmcnt(0)
    s_mul_i32 s70, s79, 0x9E3779B1
    s_add_u32 s70, s70, 0x7F4A7C15
    s_bfe_u32 s71, s70, 0x80000
    s_bfe_u32 s72, s70, 0x80008
    s_bfe_u32 s73, s70, 0x80010
    s_bfe_u32 s74, s70, 0x80018
    s_cmp_eq_u32 s56, 3
    s_cbranch_scc0 SKIP_5
    s_mov_b32 s80, 0
    s_mov_b32 s66, 2
    s_mov_b32 exec_hi, 0
CEN_6:
    buffer_load_dwordx4 v[124:127], v6, s[40:43], s65 offen sc1
    s_add_u32 s80, s80, 1
    s_waitcnt vmcnt(0)
    v_perm_b32 v86, v125, v124, s75
    v_perm_b32 v87, v127, v126, s76
    v_or_b32 v86, v86, v87
    v_cmp_ne_u32 s[88:89], s70, v86
    s_cmp_eq_u64 s[88:89], 0
    s_cbranch_scc1 CEND_7_OK
    s_cmp_lt_u32 s80, 8
    s_cbranch_scc1 CEN_6
    s_branch CEND_7
CEND_7_OK:
    v_lshrrev_b32 v86, 8, v124
    v_cmp_ne_u32 s[88:89], s64, v86
    s_cmp_eq_u64 s[88:89], 0
    s_cselect_b32 s66, 1, 2
CEND_7:
    s_mov_b64 exec, -1
    v_mov_b32 v86, 5776
    v_mov_b32 v87, s66
    ds_write_b32 v86, v87
SKIP_5:
    s_nop 0
    s_cmp_eq_u32 s56, 0
    s_cbranch_scc0 SKIP_8
    ds_read_b128 v[88:91], v6 offset:8192
    ds_read_b128 v[92:95], v6 offset:9216
    ds_read_b128 v[96:99], v6 offset:10240
    ds_read_b128 v[100:103], v6 offset:11264
    ds_read_b128 v[104:107], v6 offset:12288
    ds_read_b128 v[108:111], v6 offset:13312
    ds_read_b128 v[112:115], v6 offset:14336
    ds_read_b128 v[116:119], v6 offset:15360
    s_lshl_b32 s67, s59, 4
    s_add_u32 s67, s67, s60
    s_lshl_b32 s67, s67, 10
    s_add_u32 s67, s67, 4096
    s_waitcnt lgkmcnt(6)
    v_add_f32 v88, v88, v92
    v_add_f32 v89, v89, v93
    v_add_f32 v90, v90, v94
    v_add_f32 v91, v91, v95
    s_waitcnt lgkmcnt(5)
    v_add_f32 v88, v88, v96
    v_add_f32 v89, v89, v97
    v_add_f32 v90, v90, v98
    v_add_f32 v91, v91, v99
    s_waitcnt lgkmcnt(4)
    v_add_f32 v88, v88, v100
    v_add_f32 v89, v89, v101
    v_add_f32 v90, v90, v102
    v_add_f32 v91, v91, v103
    s_waitcnt lgkmcnt(3)
    v_add_f32 v88, v88, v104
    v_add_f32 v89, v89, v105
    v_add_f32 v90, v90, v106
    v_add_f32 v91, v91, v107
    s_waitcnt lgkmcnt(2)
    v_add_f32 v88, v88, v108
    v_add_f32 v89, v89, v109
    v_add_f32 v90, v90, v110
    v_add_f32 v91, v91, v111
    s_waitcnt lgkmcnt(1)
    v_add_f32 v88, v88, v112
    v_add_f32 v89, v89, v113
    v_add_f32 v90, v90, v114
    v_add_f32 v91, v91, v115
    s_waitcnt lgkmcnt(0)
    v_add_f32 v88, v88, v116
    v_add_f32 v89, v89, v117
    v_add_f32 v90, v90, v118
    v_add_f32 v91, v91, v119
    v_bfi_b32 v88, v16, s71, v88
    v_bfi_b32 v89, v16, s72, v89
    v_bfi_b32 v90, v16, s73, v90
    v_bfi_b32 v91, v16, s74, v91
    buffer_store_dwordx4 v[88:91], v6, s[40:43], s67 offen
    v_mov_b32 v86, 5776
    s_mov_b32 s80, 0
    s_nop 0
FLAGW_9:
    ds_read_b32 v87, v86
    s_add_u32 s80, s80, 1
    s_waitcnt lgkmcnt(0)
    v_readfirstlane_b32 s69, v87
    s_cmp_gt_u32 s80, 262144
    s_cselect_b32 s69, 2, s69
    s_cmp_eq_u32 s69, 0
    s_cbranch_scc1 FLAGW_9
    s_mov_b32 s66, s69
    s_cmp_eq_u32 s66, 1
    s_cbranch_scc1 NOMIR_10
    s_add_u32 s69, s67, 4194304
    buffer_store_dwordx4 v[88:91], v6, s[40:43], s69 offen  sc1
NOMIR_10:
SKIP_8:
    s_nop 1
    s_cmp_eq_u32 s56, 2
    s_cbranch_scc0 SKIP_11
    s_lshl_b32 s67, s59, 14
    s_lshl_b32 s68, s61, 7
    s_add_u32 s67, s67, s68
    s_add_u32 s67, s67, 4096
    s_add_u32 s68, s67, 4096
    v_mov_b32 v86, 5760
    s_mov_b32 s80, 0
    s_nop 0
FLAGW_12:
    ds_read_b32 v87, v86
    s_add_u32 s80, s80, 1
    s_waitcnt lgkmcnt(0)
    v_readfirstlane_b32 s69, v87
    s_cmp_gt_u32 s80, 262144
    s_cselect_b32 s69, 2, s69
    s_cmp_eq_u32 s69, 0
    s_cbranch_scc1 FLAGW_12
    s_mov_b32 s80, 0
    buffer_load_dwordx4 v[88:91], v78, s[40:43], s67 offen offset:0 sc1
    buffer_load_dwordx4 v[92:95], v78, s[40:43], s67 offen offset:1024 sc1
    buffer_load_dwordx4 v[96:99], v78, s[40:43], s67 offen offset:2048 sc1
    buffer_load_dwordx4 v[100:103], v78, s[40:43], s67 offen offset:3072 sc1
    buffer_load_dwordx4 v[104:107], v78, s[40:43], s68 offen offset:0 sc1
    buffer_load_dwordx4 v[108:111], v78, s[40:43], s68 offen offset:1024 sc1
    buffer_load_dwordx4 v[112:115], v78, s[40:43], s68 offen offset:2048 sc1
    buffer_load_dwordx4 v[116:119], v78, s[40:43], s68 offen offset:3072 sc1
QG_CHK_14:
    s_waitcnt vmcnt(7)
    v_perm_b32 v86, v89, v88, s75
    v_perm_b32 v87, v91, v90, s76
    v_or_b32 v86, v86, v87
    v_cmp_ne_u32 s[88:89], s70, v86
    s_waitcnt vmcnt(6)
    v_perm_b32 v86, v93, v92, s75
    v_perm_b32 v87, v95, v94, s76
    v_or_b32 v86, v86, v87
    v_cmp_ne_u32 s[90:91], s70, v86
    s_or_b64 s[88:89], s[88:89], s[90:91]
    s_waitcnt vmcnt(5)
    v_perm_b32 v86, v97, v96, s75
    v_perm_b32 v87, v99, v98, s76
    v_or_b32 v86, v86, v87
    v_cmp_ne_u32 s[90:91], s70, v86
    s_or_b64 s[88:89], s[88:89], s[90:91]
    s_waitcnt vmcnt(4)
    v_perm_b32 v86, v101, v100, s75
    v_perm_b32 v87, v103, v102, s76
    v_or_b32 v86, v86, v87
    v_cmp_ne_u32 s[90:91], s70, v86
    s_or_b64 s[88:89], s[88:89], s[90:91]
    s_waitcnt vmcnt(3)
    v_perm_b32 v86, v105, v104, s75
    v_perm_b32 v87, v107, v106, s76
    v_or_b32 v86, v86, v87
    v_cmp_ne_u32 s[90:91], s70, v86
    s_or_b64 s[88:89], s[88:89], s[90:91]
    s_waitcnt vmcnt(2)
    v_perm_b32 v86, v109, v108, s75
    v_perm_b32 v87, v111, v110, s76
    v_or_b32 v86, v86, v87
    v_cmp_ne_u32 s[90:91], s70, v86
    s_or_b64 s[88:89], s[88:89], s[90:91]
    s_waitcnt vmcnt(1)
    v_perm_b32 v86, v113, v112, s75
    v_perm_b32 v87, v115, v114, s76
    v_or_b32 v86, v86, v87
    v_cmp_ne_u32 s[90:91], s70, v86
    s_or_b64 s[88:89], s[88:89], s[90:91]
    s_waitcnt vmcnt(0)
    v_perm_b32 v86, v117, v116, s75
    v_perm_b32 v87, v119, v118, s76
    v_or_b32 v86, v86, v87
    v_cmp_ne_u32 s[90:91], s70, v86
    s_or_b64 s[88:89], s[88:89], s[90:91]
    s_cmp_eq_u64 s[88:89], 0
    s_cbranch_scc1 QG_OK_13
    s_sleep 4
    s_cmp_gt_u32 s80, 32768
    s_cbranch_scc1 QG_OK_13
    s_add_u32 s80, s80, 1
    s_and_b32 s69, s80, 1
    s_cmp_ge_u32 s80, 16
    s_cselect_b32 s69, s69, 0
    s_mul_i32 s69, s69, 4194304
    s_add_u32 s83, s67, s69
    s_add_u32 s84, s68, s69
    buffer_load_dwordx4 v[88:91], v78, s[40:43], s83 offen offset:0 sc1
    buffer_load_dwordx4 v[92:95], v78, s[40:43], s83 offen offset:1024 sc1
    buffer_load_dwordx4 v[96:99], v78, s[40:43], s83 offen offset:2048 sc1
    buffer_load_dwordx4 v[100:103], v78, s[40:43], s83 offen offset:3072 sc1
    buffer_load_dwordx4 v[104:107], v78, s[40:43], s84 offen offset:0 sc1
    buffer_load_dwordx4 v[108:111], v78, s[40:43], s84 offen offset:1024 sc1
    buffer_load_dwordx4 v[112:115], v78, s[40:43], s84 offen offset:2048 sc1
    buffer_load_dwordx4 v[116:119], v78, s[40:43], s84 offen offset:3072 sc1
    s_branch QG_CHK_14
QG_OK_13:
    v_and_b32 v88, s87, v88
    v_and_b32 v89, s87, v89
    v_and_b32 v90, s87, v90
    v_and_b32 v91, s87, v91
    v_and_b32 v92, s87, v92
    v_and_b32 v93, s87, v93
    v_and_b32 v94, s87, v94
    v_and_b32 v95, s87, v95
    v_and_b32 v96, s87, v96
    v_and_b32 v97, s87, v97
    v_and_b32 v98, s87, v98
    v_and_b32 v99, s87, v99
    v_and_b32 v100, s87, v100
    v_and_b32 v101, s87, v101
    v_and_b32 v102, s87, v102
    v_and_b32 v103, s87, v103
    v_and_b32 v104, s87, v104
    v_and_b32 v105, s87, v105
    v_and_b32 v106, s87, v106
    v_and_b32 v107, s87, v107
    v_and_b32 v108, s87, v108
    v_and_b32 v109, s87, v109
    v_and_b32 v110, s87, v110
    v_and_b32 v111, s87, v111
    v_and_b32 v112, s87, v112
    v_and_b32 v113, s87, v113
    v_and_b32 v114, s87, v114
    v_and_b32 v115, s87, v115
    v_and_b32 v116, s87, v116
    v_and_b32 v117, s87, v117
    v_and_b32 v118, s87, v118
    v_and_b32 v119, s87, v119
    v_add_f32 v88, v88, v92
    v_add_f32 v89, v89, v93
    v_add_f32 v90, v90, v94
    v_add_f32 v91, v91, v95
    v_add_f32 v88, v88, v96
    v_add_f32 v89, v89, v97
    v_add_f32 v90, v90, v98
    v_add_f32 v91, v91, v99
    v_add_f32 v88, v88, v100
    v_add_f32 v89, v89, v101
    v_add_f32 v90, v90, v102
    v_add_f32 v91, v91, v103
    v_add_f32 v88, v88, v104
    v_add_f32 v89, v89, v105
    v_add_f32 v90, v90, v106
    v_add_f32 v91, v91, v107
    v_add_f32 v88, v88, v108
    v_add_f32 v89, v89, v109
    v_add_f32 v90, v90, v110
    v_add_f32 v91, v91, v111
    v_add_f32 v88, v88, v112
    v_add_f32 v89, v89, v113
    v_add_f32 v90, v90, v114
    v_add_f32 v91, v91, v115
    v_add_f32 v88, v88, v116
    v_add_f32 v89, v89, v117
    v_add_f32 v90, v90, v118
    v_add_f32 v91, v91, v119
    v_cvt_pk_bf16_f32 v88, v88, v89
    v_cvt_pk_bf16_f32 v90, v90, v91
    ds_write_b16 v81, v88 offset:5120
    ds_write_b16_d16_hi v81, v88 offset:5136
    ds_write_b16 v81, v90 offset:5152
    ds_write_b16_d16_hi v81, v90 offset:5168
    s_waitcnt lgkmcnt(0)
SKIP_11:
    s_barrier
    s_cmp_lt_u32 s56, 3
    s_cbranch_scc0 SKIP_15
    v_mov_b32 v86, 5776
    s_mov_b32 s80, 0
    s_nop 0
FLAGW_16:
    ds_read_b32 v87, v86
    s_add_u32 s80, s80, 1
    s_waitcnt lgkmcnt(0)
    v_readfirstlane_b32 s69, v87
    s_cmp_gt_u32 s80, 262144
    s_cselect_b32 s69, 2, s69
    s_cmp_eq_u32 s69, 0
    s_cbranch_scc1 FLAGW_16
    s_mov_b32 s66, s69
SKIP_15:
    s_barrier
    s_cmp_eq_u32 s56, 1
    s_cbranch_scc0 SKIP_17
    ds_read_b128 v[88:91], v6 offset:24576
    ds_read_b128 v[92:95], v6 offset:25600
    ds_read_b128 v[96:99], v6 offset:26624
    ds_read_b128 v[100:103], v6 offset:27648
    ds_read_b128 v[104:107], v6 offset:28672
    ds_read_b128 v[108:111], v6 offset:29696
    ds_read_b128 v[112:115], v6 offset:30720
    ds_read_b128 v[116:119], v6 offset:31744
    v_lshrrev_b32 v78, 3, v3
    v_lshlrev_b32 v78, 3, v78
    ds_read_b64 v[120:121], v78 offset:5632
    ds_read_b64 v[122:123], v78 offset:5648
    ds_read_b64 v[124:125], v78 offset:5664
    ds_read_b64 v[126:127], v78 offset:5680
    ds_read_b64 v[128:129], v78 offset:5696
    ds_read_b64 v[130:131], v78 offset:5712
    ds_read_b64 v[132:133], v78 offset:5728
    ds_read_b64 v[134:135], v78 offset:5744
    s_lshl_b32 s67, s61, 4
    s_add_u32 s67, s67, s59
    s_lshl_b32 s67, s67, 3
    s_add_u32 s67, s67, s62
    s_mul_i32 s67, s67, 1152
    s_add_u32 s67, s67, 327680
    s_waitcnt lgkmcnt(0)
    v_max3_f32 v80, v120, v122, v124
    v_max3_f32 v80, v80, v126, v128
    v_max3_f32 v80, v80, v130, v132
    v_max_f32 v80, v80, v134
    v_sub_f32 v120, v120, v80
    v_sub_f32 v122, v122, v80
    v_sub_f32 v124, v124, v80
    v_sub_f32 v126, v126, v80
    v_sub_f32 v128, v128, v80
    v_sub_f32 v130, v130, v80
    v_sub_f32 v132, v132, v80
    v_sub_f32 v134, v134, v80
    v_mul_f32 v120, s78, v120
    v_mul_f32 v122, s78, v122
    v_mul_f32 v124, s78, v124
    v_mul_f32 v126, s78, v126
    v_mul_f32 v128, s78, v128
    v_mul_f32 v130, s78, v130
    v_mul_f32 v132, s78, v132
    v_mul_f32 v134, s78, v134
    v_exp_f32 v120, v120
    v_exp_f32 v122, v122
    v_exp_f32 v124, v124
    v_exp_f32 v126, v126
    v_exp_f32 v128, v128
    v_exp_f32 v130, v130
    v_exp_f32 v132, v132
    v_exp_f32 v134, v134
    v_mul_f32 v152, v88, v120
    v_mul_f32 v153, v89, v120
    v_mul_f32 v154, v90, v120
    v_mul_f32 v155, v91, v120
    v_mul_f32 v157, v121, v120
    v_fmac_f32 v152, v92, v122
    v_fmac_f32 v153, v93, v122
    v_fmac_f32 v154, v94, v122
    v_fmac_f32 v155, v95, v122
    v_fmac_f32 v157, v123, v122
    v_fmac_f32 v152, v96, v124
    v_fmac_f32 v153, v97, v124
    v_fmac_f32 v154, v98, v124
    v_fmac_f32 v155, v99, v124
    v_fmac_f32 v157, v125, v124
    v_fmac_f32 v152, v100, v126
    v_fmac_f32 v153, v101, v126
    v_fmac_f32 v154, v102, v126
    v_fmac_f32 v155, v103, v126
    v_fmac_f32 v157, v127, v126
    v_fmac_f32 v152, v104, v128
    v_fmac_f32 v153, v105, v128
    v_fmac_f32 v154, v106, v128
    v_fmac_f32 v155, v107, v128
    v_fmac_f32 v157, v129, v128
    v_fmac_f32 v152, v108, v130
    v_fmac_f32 v153, v109, v130
    v_fmac_f32 v154, v110, v130
    v_fmac_f32 v155, v111, v130
    v_fmac_f32 v157, v131, v130
    v_fmac_f32 v152, v112, v132
    v_fmac_f32 v153, v113, v132
    v_fmac_f32 v154, v114, v132
    v_fmac_f32 v155, v115, v132
    v_fmac_f32 v157, v133, v132
    v_fmac_f32 v152, v116, v134
    v_fmac_f32 v153, v117, v134
    v_fmac_f32 v154, v118, v134
    v_fmac_f32 v155, v119, v134
    v_fmac_f32 v157, v135, v134
    v_mov_b32 v156, v80
    v_mov_b32 v158, 0
    v_mov_b32 v159, 0
    v_bfi_b32 v152, v16, s71, v152
    v_bfi_b32 v153, v16, s72, v153
    v_bfi_b32 v154, v16, s73, v154
    v_bfi_b32 v155, v16, s74, v155
    v_bfi_b32 v156, v16, s71, v156
    v_bfi_b32 v157, v16, s72, v157
    v_bfi_b32 v158, v16, s73, v158
    v_bfi_b32 v159, v16, s74, v159
    v_lshlrev_b32 v81, 6, v3
    v_lshl_add_u32 v81, v4, 4, v81
    buffer_store_dwordx4 v[152:155], v81, s[40:43], s67 offen
    s_cmp_eq_u32 s66, 1
    s_cbranch_scc1 NOMIR_18
    s_add_u32 s69, s67, 4194304
    buffer_store_dwordx4 v[152:155], v81, s[40:43], s69 offen  sc1
NOMIR_18:
    v_lshlrev_b32 v78, 1, v78
    v_and_b32 v79, 0x37, v1
    v_cmp_eq_u32 vcc, 0, v79
    s_and_saveexec_b64 s[88:89], vcc
    buffer_store_dwordx4 v[156:159], v78, s[40:43], s67 offen offset:1024
    s_cmp_eq_u32 s66, 1
    s_cbranch_scc1 NOMIR_19
    s_add_u32 s69, s67, 4194304
    buffer_store_dwordx4 v[156:159], v78, s[40:43], s69 offen offset:1024 sc1
NOMIR_19:
    s_mov_b64 exec, s[88:89]
SKIP_17:
    s_nop 0
    s_cmp_eq_u32 s56, 0
    s_cbranch_scc0 SKIP_20
    v_lshrrev_b32 v78, 2, v1
    v_lshrrev_b32 v79, 3, v78
    v_and_b32 v80, 7, v78
    v_lshl_add_u32 v80, v79, 7, v80
    v_mul_u32_u24 v80, 1152, v80
    s_lshl_b32 s67, s59, 3
    s_mul_i32 s67, s67, 1152
    s_add_u32 s67, s67, 327680
    s_lshl_b32 s68, s61, 4
    v_add_u32 v81, s68, v80
    s_lshl_b32 s68, s61, 3
    s_add_u32 s68, s68, s62
    s_lshl_b32 s68, s68, 6
    v_and_b32 v82, 3, v1
    v_lshl_add_u32 v80, v82, 4, v80
    v_add_u32 v80, s68, v80
SKIP_20:
    s_nop 1
    s_cmp_eq_u32 s56, 3
    s_cbranch_scc0 SKIP_21
    v_and_b32 v78, 15, v1
    v_cmp_le_u32 vcc, 5, v78
    s_nop 1
    v_cndmask_b32 v79, 0, 1, vcc
    v_mul_u32_u24 v80, 5, v79
    v_sub_u32 v80, v78, v80
    s_mul_i32 s67, s58, 9
    s_lshr_b32 s67, s67, 1
    s_and_b32 s68, s58, 1
    s_add_u32 s68, s68, 4
    v_cmp_gt_u32 s[94:95], 10, v78
    v_cmp_gt_u32 vcc, s68, v80
    s_and_b64 s[94:95], s[94:95], vcc
    v_add_u32 v81, s67, v80
    v_lshrrev_b32 v82, 4, v81
    v_and_b32 v81, 15, v81
    v_lshlrev_b32 v152, 6, v81
    v_bfe_u32 v83, v1, 4, 1
    v_lshl_add_u32 v152, v83, 5, v152
    v_lshl_add_u32 v152, v79, 4, v152
    v_mul_u32_u24 v83, 7, v82
    v_lshrrev_b32 v83, 1, v83
    v_lshrrev_b32 v84, 5, v1
    v_add_u32 v83, v83, v84
    v_lshl_add_u32 v152, v83, 11, v152
    v_add_u32 v155, 4096, v152
    v_and_b32 v82, 1, v82
    v_xor_b32 v84, 1, v84
    v_and_b32 v82, v82, v84
    v_lshl_add_u32 v152, v82, 10, v152
    s_lshl_b32 s81, s57, 16
    s_add_u32 s81, s81, 655360
    v_mul_u32_u24 v153, 160, v79
    v_lshl_add_u32 v153, v80, 4, v153
SKIP_21:
    s_nop 1
    s_cmp_ge_u32 s56, 2
    s_cbranch_scc0 SKIP_22
    v_and_b32 v83, 7, v3
    v_lshl_add_u32 v83, v4, 3, v83
    v_lshlrev_b32 v154, 6, v83
    v_lshrrev_b32 v83, 3, v3
    v_lshl_add_u32 v154, v83, 4, v154
    s_lshl_b32 s85, s57, 5
    s_add_u32 s85, s85, s58
    s_lshl_b32 s85, s85, 11
    s_sub_u32 s68, s56, 2
    s_lshl_b32 s68, s68, 5
    s_add_u32 s85, s85, s68
    s_add_u32 s85, s85, 655360
    s_lshl_b32 s67, s58, 2
    s_mul_i32 s68, s67, 4682
    s_lshr_b32 s68, s68, 16
    s_add_u32 s69, s67, 0
    s_mul_i32 s69, s69, 4682
    s_lshr_b32 s69, s69, 16
    s_cmp_eq_u32 s69, s68
    s_cselect_b32 s48, 1.0, 0
    s_cselect_b32 s52, 0, 1.0
    s_add_u32 s69, s67, 1
    s_mul_i32 s69, s69, 4682
    s_lshr_b32 s69, s69, 16
    s_cmp_eq_u32 s69, s68
    s_cselect_b32 s49, 1.0, 0
    s_cselect_b32 s53, 0, 1.0
    s_add_u32 s69, s67, 2
    s_mul_i32 s69, s69, 4682
    s_lshr_b32 s69, s69, 16
    s_cmp_eq_u32 s69, s68
    s_cselect_b32 s50, 1.0, 0
    s_cselect_b32 s54, 0, 1.0
    s_add_u32 s69, s67, 3
    s_mul_i32 s69, s69, 4682
    s_lshr_b32 s69, s69, 16
    s_cmp_eq_u32 s69, s68
    s_cselect_b32 s51, 1.0, 0
    s_cselect_b32 s55, 0, 1.0
    s_cmp_lg_u32 s69, s68
    s_cselect_b32 s86, 1, 0
    s_cmp_lt_u32 s69, 9
    s_cselect_b32 s86, s86, 0
    s_sub_u32 s68, s56, 2
    s_lshl_b32 s68, s68, 12
    v_add_u32 v156, s68, v6
SKIP_22:
    s_barrier
    s_nop 0
    s_cmp_eq_u32 s56, 0
    s_cbranch_scc0 SKIP_23
    buffer_load_dwordx4 v[88:91], v80, s[40:43], s67 offen sc1
    buffer_load_dwordx4 v[92:95], v81, s[40:43], s67 offen offset:1024 sc1
SKIP_23:
    s_cmp_ge_u32 s56, 2
    s_cbranch_scc0 SKIP_24
    ds_read_b128 v[88:91], v156 offset:32768
    ds_read_b128 v[92:95], v156 offset:33792
    ds_read_b128 v[96:99], v156 offset:34816
    ds_read_b128 v[100:103], v156 offset:35840
    s_cmp_eq_u32 s86, 0
    s_cbranch_scc1 NOB_25
    s_waitcnt lgkmcnt(0)
    v_mul_f32 v112, s55, v100
    v_mul_f32 v113, s55, v101
    v_mul_f32 v114, s55, v102
    v_mul_f32 v115, s55, v103
    v_fmac_f32 v112, s53, v92
    v_fmac_f32 v113, s53, v93
    v_fmac_f32 v114, s53, v94
    v_fmac_f32 v115, s53, v95
    v_fmac_f32 v112, s54, v96
    v_fmac_f32 v113, s54, v97
    v_fmac_f32 v114, s54, v98
    v_fmac_f32 v115, s54, v99
    v_mul_f32 v104, s49, v92
    v_mul_f32 v105, s49, v93
    v_mul_f32 v106, s49, v94
    v_mul_f32 v107, s49, v95
    v_add_f32 v104, v104, v88
    v_add_f32 v105, v105, v89
    v_add_f32 v106, v106, v90
    v_add_f32 v107, v107, v91
    v_fmac_f32 v104, s50, v96
    v_fmac_f32 v105, s50, v97
    v_fmac_f32 v106, s50, v98
    v_fmac_f32 v107, s50, v99
    v_fmac_f32 v104, s51, v100
    v_fmac_f32 v105, s51, v101
    v_fmac_f32 v106, s51, v102
    v_fmac_f32 v107, s51, v103
    v_mov_b32 v116, v112
    v_mov_b32 v117, v113
    v_mov_b32 v118, v114
    v_mov_b32 v119, v115
    v_permlane32_swap_b32 v112, v116
    v_permlane32_swap_b32 v113, v117
    v_permlane32_swap_b32 v114, v118
    v_permlane32_swap_b32 v115, v119
    v_add_f32 v112, v112, v116
    v_add_f32 v113, v113, v117
    v_add_f32 v114, v114, v118
    v_add_f32 v115, v115, v119
    v_bfi_b32 v112, v16, s71, v112
    v_bfi_b32 v113, v16, s72, v113
    v_bfi_b32 v114, v16, s73, v114
    v_bfi_b32 v115, v16, s74, v115
    s_add_u32 s67, s85, 1024
    s_mov_b32 exec_hi, 0
    buffer_store_dwordx4 v[112:115], v154, s[40:43], s67 offen
    s_cmp_eq_u32 s66, 1
    s_cbranch_scc1 NOMIR_27
    s_add_u32 s69, s67, 4194304
    buffer_store_dwordx4 v[112:115], v154, s[40:43], s69 offen  sc1
NOMIR_27:
    s_mov_b64 exec, -1
    s_branch PUBE_26
NOB_25:
    s_waitcnt lgkmcnt(2)
    v_add_f32 v104, v88, v92
    v_add_f32 v105, v89, v93
    v_add_f32 v106, v90, v94
    v_add_f32 v107, v91, v95
    s_waitcnt lgkmcnt(0)
    v_add_f32 v96, v96, v100
    v_add_f32 v97, v97, v101
    v_add_f32 v98, v98, v102
    v_add_f32 v99, v99, v103
    v_add_f32 v104, v104, v96
    v_add_f32 v105, v105, v97
    v_add_f32 v106, v106, v98
    v_add_f32 v107, v107, v99
PUBE_26:
    v_mov_b32 v108, v104
    v_mov_b32 v109, v105
    v_mov_b32 v110, v106
    v_mov_b32 v111, v107
    v_permlane32_swap_b32 v104, v108
    v_permlane32_swap_b32 v105, v109
    v_permlane32_swap_b32 v106, v110
    v_permlane32_swap_b32 v107, v111
    v_add_f32 v104, v104, v108
    v_add_f32 v105, v105, v109
    v_add_f32 v106, v106, v110
    v_add_f32 v107, v107, v111
    v_bfi_b32 v104, v16, s71, v104
    v_bfi_b32 v105, v16, s72, v105
    v_bfi_b32 v106, v16, s73, v106
    v_bfi_b32 v107, v16, s74, v107
    s_mov_b32 exec_hi, 0
    buffer_store_dwordx4 v[104:107], v154, s[40:43], s85 offen
    s_cmp_eq_u32 s66, 1
    s_cbranch_scc1 NOMIR_28
    s_add_u32 s69, s85, 4194304
    buffer_store_dwordx4 v[104:107], v154, s[40:43], s69 offen  sc1
NOMIR_28:
    s_mov_b64 exec, -1
SKIP_24:
    s_barrier
    s_cmp_eq_u32 s56, 3
    s_cbranch_scc0 SKIP_29
    s_mov_b64 s[92:93], exec
    s_mov_b64 exec, s[94:95]
    s_barrier
    buffer_load_dwordx4 v[120:123], v152, s[40:43], s81 offen sc1
    buffer_load_dwordx4 v[124:127], v155, s[40:43], s81 offen sc1
    s_barrier
    s_branch H3J_30
SKIP_29:
    s_barrier
    s_barrier
H3J_30:
    s_cmp_eq_u32 s56, 0
    s_cbranch_scc0 SKIP_31
    s_mov_b32 s80, 0
OG_CHK_33:
    s_waitcnt vmcnt(1)
    v_perm_b32 v86, v89, v88, s75
    v_perm_b32 v87, v91, v90, s76
    v_or_b32 v86, v86, v87
    v_cmp_ne_u32 s[88:89], s70, v86
    s_waitcnt vmcnt(0)
    v_perm_b32 v86, v93, v92, s75
    v_perm_b32 v87, v95, v94, s76
    v_or_b32 v86, v86, v87
    v_cmp_ne_u32 s[90:91], s70, v86
    s_or_b64 s[88:89], s[88:89], s[90:91]
    s_cmp_eq_u64 s[88:89], 0
    s_cbranch_scc1 OG_OK_32
    s_cmp_gt_u32 s80, 32768
    s_cbranch_scc1 OG_OK_32
    s_add_u32 s80, s80, 1
    s_and_b32 s69, s80, 1
    s_cmp_ge_u32 s80, 16
    s_cselect_b32 s69, s69, 0
    s_mul_i32 s69, s69, 4194304
    s_add_u32 s83, s67, s69
    buffer_load_dwordx4 v[88:91], v80, s[40:43], s83 offen sc1
    buffer_load_dwordx4 v[92:95], v81, s[40:43], s83 offen offset:1024 sc1
    s_branch OG_CHK_33
OG_OK_32:
    v_and_b32 v88, s87, v88
    v_and_b32 v89, s87, v89
    v_and_b32 v90, s87, v90
    v_and_b32 v91, s87, v91
    v_and_b32 v92, s87, v92
    v_and_b32 v93, s87, v93
    v_mov_b32 v83, v92
    s_nop 1
    v_max_f32_dpp v83, v83, v83 row_ror:4 row_mask:0xf bank_mask:0xf
    s_nop 1
    v_max_f32_dpp v83, v83, v83 row_ror:8 row_mask:0xf bank_mask:0xf
    v_mov_b32 v84, v83
    s_nop 1
    v_permlane16_swap_b32 v83, v84
    v_max_f32 v83, v83, v84
    v_sub_f32 v84, v92, v83
    v_mul_f32 v84, s78, v84
    v_exp_f32 v84, v84
    s_nop 0
    v_mul_f32 v88, v88, v84
    v_mul_f32 v89, v89, v84
    v_mul_f32 v90, v90, v84
    v_mul_f32 v91, v91, v84
    v_mul_f32 v93, v93, v84
    v_add_f32_dpp v88, v88, v88 row_ror:4 row_mask:0xf bank_mask:0xf
    v_add_f32_dpp v89, v89, v89 row_ror:4 row_mask:0xf bank_mask:0xf
    v_add_f32_dpp v90, v90, v90 row_ror:4 row_mask:0xf bank_mask:0xf
    v_add_f32_dpp v91, v91, v91 row_ror:4 row_mask:0xf bank_mask:0xf
    v_add_f32_dpp v93, v93, v93 row_ror:4 row_mask:0xf bank_mask:0xf
    v_add_f32_dpp v88, v88, v88 row_ror:8 row_mask:0xf bank_mask:0xf
    v_add_f32_dpp v89, v89, v89 row_ror:8 row_mask:0xf bank_mask:0xf
    v_add_f32_dpp v90, v90, v90 row_ror:8 row_mask:0xf bank_mask:0xf
    v_add_f32_dpp v91, v91, v91 row_ror:8 row_mask:0xf bank_mask:0xf
    v_add_f32_dpp v93, v93, v93 row_ror:8 row_mask:0xf bank_mask:0xf
    v_mov_b32 v96, v88
    v_mov_b32 v97, v89
    v_mov_b32 v98, v90
    v_mov_b32 v99, v91
    v_mov_b32 v100, v93
    v_permlane16_swap_b32 v88, v96
    v_permlane16_swap_b32 v89, v97
    v_permlane16_swap_b32 v90, v98
    v_permlane16_swap_b32 v91, v99
    v_permlane16_swap_b32 v93, v100
    v_add_f32 v88, v88, v96
    v_add_f32 v89, v89, v97
    v_add_f32 v90, v90, v98
    v_add_f32 v91, v91, v99
    v_add_f32 v93, v93, v100
    v_rcp_f32 v93, v93
    s_nop 0
    v_mul_f32 v88, v88, v93
    v_mul_f32 v89, v89, v93
    v_mul_f32 v90, v90, v93
    v_mul_f32 v91, v91, v93
    v_cvt_pk_bf16_f32 v88, v88, v88
    v_cvt_pk_bf16_f32 v89, v89, v89
    v_cvt_pk_bf16_f32 v90, v90, v90
    v_cvt_pk_bf16_f32 v91, v91, v91
    v_lshrrev_b32 v78, 5, v1
    v_mul_u32_u24 v78, 160, v78
    v_lshl_add_u32 v78, v82, 4, v78
    v_and_b32 v79, 0x1c, v1
    v_cmp_eq_u32 vcc, 0, v79
    s_and_saveexec_b64 s[88:89], vcc
    ds_write_b128 v78, v[88:91] offset:4608
    s_mov_b64 exec, s[88:89]
SKIP_31:
    s_nop 1
    s_cmp_eq_u32 s56, 3
    s_cbranch_scc0 SKIP_34
    s_mov_b32 s80, 0
HG_PIPE_37:
    s_add_u32 s80, s80, 1
    buffer_load_dwordx4 v[120:123], v152, s[40:43], s81 offen sc1
    buffer_load_dwordx4 v[124:127], v155, s[40:43], s81 offen sc1
    s_waitcnt vmcnt(3)
    v_perm_b32 v86, v121, v120, s75
    v_perm_b32 v87, v123, v122, s76
    v_or_b32 v86, v86, v87
    v_cmp_ne_u32 s[88:89], s70, v86
    s_waitcnt vmcnt(2)
    v_perm_b32 v86, v125, v124, s75
    v_perm_b32 v87, v127, v126, s76
    v_or_b32 v86, v86, v87
    v_cmp_ne_u32 s[90:91], s70, v86
    s_or_b64 s[88:89], s[88:89], s[90:91]
    s_cmp_eq_u64 s[88:89], 0
    s_cbranch_scc1 HG_OK_35
    s_cmp_lt_u32 s80, 15
    s_cbranch_scc1 HG_PIPE_37
HG_CHK_36:
    s_waitcnt vmcnt(1)
    v_perm_b32 v86, v121, v120, s75
    v_perm_b32 v87, v123, v122, s76
    v_or_b32 v86, v86, v87
    v_cmp_ne_u32 s[88:89], s70, v86
    s_waitcnt vmcnt(0)
    v_perm_b32 v86, v125, v124, s75
    v_perm_b32 v87, v127, v126, s76
    v_or_b32 v86, v86, v87
    v_cmp_ne_u32 s[90:91], s70, v86
    s_or_b64 s[88:89], s[88:89], s[90:91]
    s_cmp_eq_u64 s[88:89], 0
    s_cbranch_scc1 HG_OK_35
    s_cmp_gt_u32 s80, 32768
    s_cbranch_scc1 HG_OK_35
    s_add_u32 s80, s80, 1
    s_and_b32 s69, s80, 1
    s_cmp_ge_u32 s80, 16
    s_cselect_b32 s69, s69, 0
    s_mul_i32 s69, s69, 4194304
    s_add_u32 s83, s81, s69
    buffer_load_dwordx4 v[120:123], v152, s[40:43], s83 offen sc1
    buffer_load_dwordx4 v[124:127], v155, s[40:43], s83 offen sc1
    s_branch HG_CHK_36
HG_OK_35:
    s_mov_b64 exec, s[92:93]
    v_and_b32 v128, s87, v120
    v_and_b32 v129, s87, v121
    v_and_b32 v130, s87, v122
    v_and_b32 v131, s87, v123
    v_and_b32 v132, s87, v124
    v_and_b32 v133, s87, v125
    v_and_b32 v134, s87, v126
    v_and_b32 v135, s87, v127
    v_add_f32 v128, v128, v132
    v_add_f32 v129, v129, v133
    v_add_f32 v130, v130, v134
    v_add_f32 v131, v131, v135
    v_mov_b32 v132, v128
    v_mov_b32 v133, v129
    v_mov_b32 v134, v130
    v_mov_b32 v135, v131
    v_permlane32_swap_b32 v128, v132
    v_permlane32_swap_b32 v129, v133
    v_permlane32_swap_b32 v130, v134
    v_permlane32_swap_b32 v131, v135
    v_add_f32 v128, v128, v132
    v_add_f32 v129, v129, v133
    v_add_f32 v130, v130, v134
    v_add_f32 v131, v131, v135
    v_mov_b32 v132, v128
    v_mov_b32 v133, v129
    v_mov_b32 v134, v130
    v_mov_b32 v135, v131
    v_permlane16_swap_b32 v128, v132
    v_permlane16_swap_b32 v129, v133
    v_permlane16_swap_b32 v130, v134
    v_permlane16_swap_b32 v131, v135
    v_cvt_pk_bf16_f32 v128, v128, v132
    v_cvt_pk_bf16_f32 v129, v129, v133
    v_cvt_pk_bf16_f32 v130, v130, v134
    v_cvt_pk_bf16_f32 v131, v131, v135
    v_lshlrev_b32 v132, 16, v128
    v_and_b32 v128, 0xffff0000, v128
    v_lshlrev_b32 v133, 16, v129
    v_and_b32 v129, 0xffff0000, v129
    v_lshlrev_b32 v134, 16, v130
    v_and_b32 v130, 0xffff0000, v130
    v_lshlrev_b32 v135, 16, v131
    v_and_b32 v131, 0xffff0000, v131
    v_max_f32 v132, 0, v132
    v_max_f32 v133, 0, v133
    v_max_f32 v134, 0, v134
    v_max_f32 v135, 0, v135
    v_mul_f32 v128, v128, v132
    v_mul_f32 v129, v129, v133
    v_mul_f32 v130, v130, v134
    v_mul_f32 v131, v131, v135
    v_cvt_pk_bf16_f32 v128, v128, v128
    v_cvt_pk_bf16_f32 v129, v129, v129
    v_cvt_pk_bf16_f32 v130, v130, v130
    v_cvt_pk_bf16_f32 v131, v131, v131
    v_cndmask_b32 v128, 0, v128, s[94:95]
    v_cndmask_b32 v129, 0, v129, s[94:95]
    v_cndmask_b32 v130, 0, v130, s[94:95]
    v_cndmask_b32 v131, 0, v131, s[94:95]
    v_cmp_gt_u32 vcc, 10, v1
    s_and_saveexec_b64 s[88:89], vcc
    ds_write_b128 v153, v[128:131] offset:4672
    s_mov_b64 exec, s[88:89]
SKIP_34:
    s_waitcnt lgkmcnt(0)
    s_barrier
    s_branch FIN
CODE_END:
.section .rodata,"a"
.p2align 6
.amdhsa_kernel parallel_sum__sliding_block_cached__glu_gated_reglu__decode_kernel
  .amdhsa_next_free_vgpr 168
  .amdhsa_next_free_sgpr 102
  .amdhsa_accum_offset 168
  .amdhsa_group_segment_fixed_size 0
  .amdhsa_kernarg_size 96
  .amdhsa_user_sgpr_count 2
  .amdhsa_user_sgpr_kernarg_segment_ptr 1
  .amdhsa_system_sgpr_workgroup_id_x 1
  .amdhsa_float_denorm_mode_32 3
.end_amdhsa_kernel
```
